```python
import torch

def _softmax(x, axis=-1):
    return torch.softmax(x, dim=axis)
def _gelu(x):
    return torch.nn.functional.gelu(x, approximate="tanh")
def _silu(x):
    return torch.nn.functional.silu(x)
def _sigmoid(x):
    return torch.sigmoid(x)
def _layernorm(x, axis=-1, eps=1e-5):
    m = x.mean(dim=axis, keepdim=True)
    v = x.var(dim=axis, keepdim=True, unbiased=False)
    return (x - m) / torch.sqrt(v + eps)
def _scatter_add(tgt, idx, src, axis=0):
    return tgt.clone().index_add_(axis, idx, src)
def _segment_sum(src, seg, n):
    out = torch.zeros((n,) + src.shape[1:], dtype=src.dtype)
    return out.index_add_(0, seg, src)
def _pad(x, pw):
    flat = tuple(v for pair in reversed(pw) for v in pair)
    return torch.nn.functional.pad(x, flat)

kernel_name = 'standalone__batchnorm__sampling'

def setup_inputs():

    _w = (lambda a: (lambda t: t.to(torch.bfloat16) if t.is_floating_point() else t)(torch.as_tensor(a)))
    B, S, C = 1024, 8, 640
    K = 3
    return {
        "x": _w((lambda *s: torch.randn(*s, dtype=torch.bfloat16) * 0.05)(B, S, C)),
        "w": _w((lambda *s: torch.randn(*s, dtype=torch.bfloat16) * 0.05)(K, C, C) * (1.0 / (K * C) ** 0.5)),
        "mean": _w((lambda *s: torch.randn(*s, dtype=torch.bfloat16) * 0.05)(C) * 0.1),
        "var": _w(torch.abs((lambda *s: torch.randn(*s, dtype=torch.bfloat16) * 0.05)(C)) + 0.5),
        "g": _w((lambda *s: torch.randn(*s, dtype=torch.bfloat16) * 0.05)(C) + 1.0),
        "b": _w((lambda *s: torch.randn(*s, dtype=torch.bfloat16) * 0.05)(C) * 0.1),
    }

def reference(x, w, mean, var, g, b):
    K = 3
    P = K // 2
    S = x.shape[1]
    xp = _pad(x, ((0, 0), (P, P), (0, 0)))
    y = sum(torch.einsum('bsc,cd->bsd', xp[:, k:k + S, :], w[k]) for k in range(K))
    inv_std = 1.0 / torch.sqrt(var + 1e-5)
    y = (y - mean) * (g * inv_std) + b
    return _silu(y)
```

```asm
; @launch grid=(256,1,1) block=(512,1,1) lds=163840
.amdgcn_target "amdgcn-amd-amdhsa--gfx950"
.text
.globl standalone__batchnorm__sampling_kernel
.p2align 8
.type standalone__batchnorm__sampling_kernel,@function
standalone__batchnorm__sampling_kernel:
s_cmp_ge_u32 s2, 256
s_cbranch_scc1 L_end
s_load_dwordx8 s[4:11], s[0:1], 0
s_load_dwordx4 s[12:15], s[0:1], 32
s_load_dwordx2 s[16:17], s[0:1], 48
s_getpc_b64 s[54:55]
L_pc:
v_lshrrev_b32 v1, 6, v0
v_and_b32 v2, 63, v0
v_lshl_add_u32 v3, v1, 4, v2
v_lshlrev_b32 v3, 7, v3
s_sub_u32 s54, s54, L_pc-standalone__batchnorm__sampling_kernel
s_subb_u32 s55, s55, 0
v_cmp_gt_u32 vcc, 16, v2
v_min_u32 v3, L_end-standalone__batchnorm__sampling_kernel, v3
v_mov_b32 v5, s55
s_mov_b64 s[56:57], vcc
v_add_co_u32 v4, vcc, s54, v3
v_addc_co_u32 v5, vcc, 0, v5, vcc
s_mov_b64 exec, s[56:57]
global_load_dword v129, v[4:5], off
s_mov_b64 exec, -1
v_lshrrev_b32 v1, 6, v0
v_and_b32 v0, 63, v0
s_and_b32 s33, s2, 7
v_readfirstlane_b32 s32, v1
s_lshr_b32 s34, s2, 3
s_lshr_b32 s35, s34, 3
s_and_b32 s34, s34, 7
s_mul_i32 s84, s33, 5
s_lshr_b32 s84, s84, 2
s_lshl_b32 s33, s33, 2
s_add_u32 s33, s33, s35
s_mov_b32 s85, s32
s_and_b32 s32, s32, 3
v_lshrrev_b32 v2, 4, v0
v_lshrrev_b32 v5, 3, v0
v_and_b32 v6, 7, v0
v_xor_b32 v6, v6, v2
v_mul_u32_u24 v5, 10240, v5
v_lshlrev_b32 v7, 4, v6
v_xor_b32 v6, 4, v6
v_lshlrev_b32 v6, 4, v6
v_add_u32 v8, v5, v7
v_add_u32 v9, v5, v6
v_add_u32 v9, 80896, v9
v_add_u32 v10, 161792, v8
v_add_u32 v11, 161792, v9
s_mul_i32 s37, s33, 327680
s_mul_i32 s45, s32, 1280
s_add_u32 s37, s37, s45
s_add_u32 s59, s37, 5120
s_lshl_b32 s40, s32, 12
s_add_u32 s40, s40, 65536
s_add_u32 s41, s40, 16384
s_mul_i32 s42, s32, 3840
s_lshl_b32 s58, s84, 7
s_mul_i32 s38, s84, 81920
s_mov_b32 s22, 10485760
s_mov_b32 s23, 0x20000
s_mov_b32 s26, 2457600
s_mov_b32 s27, 0x20000
s_waitcnt lgkmcnt(0)
s_cmp_lt_u32 s85, 4
s_cbranch_scc1 L_early
s_mov_b32 s20, s4
s_mov_b32 s21, s5
s_mov_b32 s24, s6
s_mov_b32 s25, s7
s_add_u32 m0, s40, 0
s_add_u32 s56, s37, s58
buffer_load_dwordx4 v8, s[20:23], s56 offen offset:0  lds
buffer_load_dwordx4 v9, s[20:23], s56 offen offset:1024  lds
buffer_load_dwordx4 v10, s[20:23], s56 offen offset:2048  lds
buffer_load_dwordx4 v11, s[20:23], s56 offen offset:3072  lds
s_add_u32 m0, s41, 0
s_add_u32 s56, s59, s58
buffer_load_dwordx4 v8, s[20:23], s56 offen offset:0  lds
buffer_load_dwordx4 v9, s[20:23], s56 offen offset:1024  lds
buffer_load_dwordx4 v10, s[20:23], s56 offen offset:2048  lds
buffer_load_dwordx4 v11, s[20:23], s56 offen offset:3072  lds
s_add_u32 s58, s58, 128
s_cmp_eq_u32 s58, 1280
s_cselect_b32 s58, 0, s58
s_branch L_loader2
L_early:
s_lshr_b32 s35, s32, 1
s_and_b32 s36, s32, 1
s_cmp_eq_u32 s32, 0
s_cbranch_scc0 L_noparam
s_lshl_b32 s44, s34, 7
s_lshl_b32 s46, s34, 5
s_add_u32 s46, s46, 896
v_cmp_gt_u32 vcc, 32, v0
v_mov_b32 v4, s46
v_mov_b32 v12, s44
v_lshlrev_b32 v1, 2, v0
v_cndmask_b32 v4, v4, v12, vcc
v_add_u32 v1, v4, v1
s_mov_b32 exec_hi, 0xff
s_waitcnt lgkmcnt(0)
global_load_dword v92, v1, s[8:9]
global_load_dword v93, v1, s[10:11]
global_load_dword v94, v1, s[12:13]
global_load_dword v95, v1, s[14:15]
s_mov_b64 exec, -1
L_noparam:
s_cmp_eq_u32 s36, 1
s_cbranch_scc1 L_tw
s_lshl_b32 s45, s35, 4
v_add_u32 v128, s45, v0
v_lshrrev_b32 v4, 3, v128
v_and_b32 v128, 7, v128
v_mul_u32_u24 v128, 1280, v128
s_lshl_b32 s45, s34, 2
v_add_u32 v4, s45, v4
v_mul_u32_u24 v4, 10240, v4
v_add_u32 v128, v128, v4
s_mul_i32 s45, s33, 327680
v_add_u32 v128, s45, v128
v_cmp_gt_u32 vcc, 16, v0
s_mov_b32 s48, 128
s_mov_b32 s49, 1280
s_waitcnt lgkmcnt(0)
s_mov_b32 s20, s4
s_mov_b32 s21, s5
s_mov_b32 s22, 10485760
s_branch L_tj
L_tw:
s_lshr_b32 s45, s2, 3
s_mul_i32 s45, s45, 60
s_mul_i32 s46, s35, 30
s_add_u32 s45, s45, s46
v_add_u32 v128, s45, v0
v_mul_u32_u24 v4, 0xcccd, v128
v_lshrrev_b32 v4, 19, v4
v_mul_u32_u24 v1, 10, v4
v_sub_u32 v128, v128, v1
v_lshlrev_b32 v128, 7, v128
v_lshrrev_b32 v1, 6, v4
v_and_b32 v4, 63, v4
v_mul_u32_u24 v1, 819200, v1
v_mul_u32_u24 v4, 1280, v4
v_add3_u32 v128, v128, v1, v4
v_cmp_gt_u32 vcc, 30, v0
s_mov_b32 s48, 81920
s_mov_b32 s49, 819200
s_waitcnt lgkmcnt(0)
s_mov_b32 s20, s6
s_mov_b32 s21, s7
s_mov_b32 s22, 2457600
L_tj:
s_mov_b32 s23, 0x20000
v_mov_b32 v4, 0x7ff00000
v_cndmask_b32 v128, v4, v128, vcc
s_cmp_eq_u32 s36, 0
s_cbranch_scc1 L_tsk0
s_add_u32 s45, s84, 0
s_cmp_ge_u32 s45, 10
s_cselect_b32 s46, 10, 0
s_sub_u32 s45, s45, s46
s_mul_i32 s45, s45, s48
buffer_load_dword v129, v128, s[20:23], s45 offen
L_tsk0:
s_cmp_eq_u32 s36, 0
s_cbranch_scc1 L_tsk1
s_add_u32 s45, s84, 1
s_cmp_ge_u32 s45, 10
s_cselect_b32 s46, 10, 0
s_sub_u32 s45, s45, s46
s_mul_i32 s45, s45, s48
buffer_load_dword v129, v128, s[20:23], s45 offen
L_tsk1:
s_add_u32 s57, s84, 3
s_cmp_ge_u32 s57, 10
s_cselect_b32 s46, 10, 0
s_sub_u32 s57, s57, s46
s_mul_i32 s57, s57, s48
s_lshl_b32 s44, s34, 5
s_mul_i32 s45, s32, 6
s_add_u32 s44, s44, s45
s_mul_i32 s44, s44, 1280
s_mul_i32 s45, s33, 327680
s_add_u32 s44, s44, s45
s_add_u32 s87, s84, 1
s_cmp_ge_u32 s87, 10
s_cselect_b32 s45, 10, 0
s_sub_u32 s87, s87, s45
s_lshl_b32 s87, s87, 7
s_add_u32 s44, s44, s87
s_add_u32 s92, s4, s44
s_addc_u32 s93, s5, 0
s_load_dword s90, s[92:93], 0
s_load_dword s90, s[92:93], 64
s_load_dword s90, s[92:93], 1280
s_load_dword s90, s[92:93], 1344
s_load_dword s90, s[92:93], 2560
s_load_dword s90, s[92:93], 2624
s_load_dword s90, s[92:93], 3840
s_load_dword s90, s[92:93], 3904
s_load_dword s90, s[92:93], 5120
s_load_dword s90, s[92:93], 5184
s_load_dword s90, s[92:93], 6400
s_load_dword s90, s[92:93], 6464
s_branch L_compute
L_loader2:
v_mul_u32_u24 v5, 0x199a, v0
v_lshrrev_b32 v5, 16, v5
v_mul_u32_u24 v6, 10, v5
v_sub_u32 v6, v0, v6
s_lshl_b32 s44, s34, 7
s_lshl_b32 s46, s34, 5
s_add_u32 s46, s46, 896
v_cmp_gt_u32 vcc, 8, v6
v_mov_b32 v19, s46
v_mov_b32 v20, s44
s_mul_i32 s45, s32, 24
s_mov_b32 s43, 778240
s_movk_i32 s44, 1280
s_movk_i32 s46, -640
v_cndmask_b32 v19, v19, v20, vcc
v_lshl_add_u32 v19, v6, 4, v19
v_add_u32 v5, s45, v5
v_mad_u32_u24 v6, v5, s44, v19
v_lshrrev_b32 v7, 5, v5
v_mad_u32_u24 v6, v7, s43, v6
v_and_b32 v7, 4, v5
v_mad_u32_u24 v6, v7, s44, v6
v_and_b32 v7, 8, v5
v_mad_i32_i24 v12, v7, s46, v6
v_add_u32 v5, 6, v5
v_subrev_u32 v19, 960, v19
v_mad_u32_u24 v6, v5, s44, v19
v_lshrrev_b32 v7, 5, v5
v_mad_u32_u24 v6, v7, s43, v6
v_and_b32 v7, 4, v5
v_mad_u32_u24 v6, v7, s44, v6
v_and_b32 v7, 8, v5
v_mad_i32_i24 v13, v7, s46, v6
v_add_u32 v5, 6, v5
v_subrev_u32 v19, 960, v19
v_mad_u32_u24 v6, v5, s44, v19
v_lshrrev_b32 v7, 5, v5
v_mad_u32_u24 v6, v7, s43, v6
v_and_b32 v7, 4, v5
v_mad_u32_u24 v6, v7, s44, v6
v_and_b32 v7, 8, v5
v_mad_i32_i24 v14, v7, s46, v6
v_add_u32 v5, 6, v5
v_subrev_u32 v19, 960, v19
v_min_u32 v5, 95, v5
v_mad_u32_u24 v6, v5, s44, v19
v_lshrrev_b32 v7, 5, v5
v_mad_u32_u24 v6, v7, s43, v6
v_and_b32 v7, 4, v5
v_mad_u32_u24 v6, v7, s44, v6
v_and_b32 v7, 8, v5
v_mad_i32_i24 v15, v7, s46, v6
s_add_u32 m0, s42, 0
s_mov_b32 exec_hi, 0x0fffffff
buffer_load_dwordx4 v12, s[24:27], s38 offen offset:0  lds
buffer_load_dwordx4 v13, s[24:27], s38 offen offset:960  lds
buffer_load_dwordx4 v14, s[24:27], s38 offen offset:1920  lds
buffer_load_dwordx4 v15, s[24:27], s38 offen offset:2880  lds
s_mov_b32 exec_hi, -1
s_add_u32 s38, s38, 40960
s_cmp_eq_u32 s38, 819200
s_cselect_b32 s38, 0, s38
s_lshl_b32 s44, s34, 5
s_mul_i32 s45, s32, 2
s_add_u32 s44, s44, s45
s_add_u32 s44, s44, 24
s_mul_i32 s44, s44, 1280
s_mul_i32 s45, s33, 327680
s_add_u32 s44, s44, s45
s_add_u32 s87, s84, 1
s_cmp_ge_u32 s87, 10
s_cselect_b32 s45, 10, 0
s_sub_u32 s87, s87, s45
s_lshl_b32 s87, s87, 7
s_add_u32 s44, s44, s87
s_add_u32 s92, s4, s44
s_addc_u32 s93, s5, 0
s_load_dword s90, s[92:93], 0
s_load_dword s90, s[92:93], 64
s_load_dword s90, s[92:93], 1280
s_load_dword s90, s[92:93], 1344
s_lshl_b32 s44, s34, 5
s_mul_i32 s45, s32, 8
s_add_u32 s44, s44, s45
s_add_u32 s44, s44, 0
s_mul_i32 s44, s44, 1280
s_mul_i32 s45, s33, 327680
s_add_u32 s44, s44, s45
s_add_u32 s87, s84, 2
s_cmp_ge_u32 s87, 10
s_cselect_b32 s45, 10, 0
s_sub_u32 s87, s87, s45
s_lshl_b32 s87, s87, 7
s_add_u32 s44, s44, s87
s_add_u32 s92, s4, s44
s_addc_u32 s93, s5, 0
s_load_dword s90, s[92:93], 0
s_load_dword s90, s[92:93], 64
s_load_dword s90, s[92:93], 1280
s_load_dword s90, s[92:93], 1344
s_load_dword s90, s[92:93], 2560
s_load_dword s90, s[92:93], 2624
s_load_dword s90, s[92:93], 3840
s_load_dword s90, s[92:93], 3904
s_add_u32 m0, s42, 16384
s_mov_b32 exec_hi, 0x0fffffff
buffer_load_dwordx4 v12, s[24:27], s38 offen offset:0  lds
buffer_load_dwordx4 v13, s[24:27], s38 offen offset:960  lds
buffer_load_dwordx4 v14, s[24:27], s38 offen offset:1920  lds
buffer_load_dwordx4 v15, s[24:27], s38 offen offset:2880  lds
s_mov_b32 exec_hi, -1
s_add_u32 s38, s38, 40960
s_cmp_eq_u32 s38, 819200
s_cselect_b32 s38, 0, s38
s_add_u32 m0, s40, 32768
s_add_u32 s56, s37, s58
buffer_load_dwordx4 v8, s[20:23], s56 offen offset:0  lds
buffer_load_dwordx4 v9, s[20:23], s56 offen offset:1024  lds
buffer_load_dwordx4 v10, s[20:23], s56 offen offset:2048  lds
buffer_load_dwordx4 v11, s[20:23], s56 offen offset:3072  lds
s_waitcnt vmcnt(8)
s_barrier
s_add_u32 m0, s42, 32768
s_mov_b32 exec_hi, 0x0fffffff
buffer_load_dwordx4 v12, s[24:27], s38 offen offset:0  lds
buffer_load_dwordx4 v13, s[24:27], s38 offen offset:960  lds
buffer_load_dwordx4 v14, s[24:27], s38 offen offset:1920  lds
buffer_load_dwordx4 v15, s[24:27], s38 offen offset:2880  lds
s_mov_b32 exec_hi, -1
s_add_u32 s38, s38, 40960
s_cmp_eq_u32 s38, 819200
s_cselect_b32 s38, 0, s38
s_waitcnt lgkmcnt(7)
s_lshl_b32 s44, s34, 5
s_mul_i32 s45, s32, 8
s_add_u32 s44, s44, s45
s_add_u32 s44, s44, 4
s_mul_i32 s44, s44, 1280
s_mul_i32 s45, s33, 327680
s_add_u32 s44, s44, s45
s_add_u32 s87, s84, 2
s_cmp_ge_u32 s87, 10
s_cselect_b32 s45, 10, 0
s_sub_u32 s87, s87, s45
s_lshl_b32 s87, s87, 7
s_add_u32 s44, s44, s87
s_add_u32 s92, s4, s44
s_addc_u32 s93, s5, 0
s_load_dword s90, s[92:93], 0
s_load_dword s90, s[92:93], 64
s_load_dword s90, s[92:93], 1280
s_load_dword s90, s[92:93], 1344
s_load_dword s90, s[92:93], 2560
s_load_dword s90, s[92:93], 2624
s_load_dword s90, s[92:93], 3840
s_load_dword s90, s[92:93], 3904
s_waitcnt vmcnt(8)
s_barrier
s_add_u32 m0, s41, 32768
s_add_u32 s56, s59, s58
buffer_load_dwordx4 v8, s[20:23], s56 offen offset:0  lds
buffer_load_dwordx4 v9, s[20:23], s56 offen offset:1024  lds
buffer_load_dwordx4 v10, s[20:23], s56 offen offset:2048  lds
buffer_load_dwordx4 v11, s[20:23], s56 offen offset:3072  lds
s_add_u32 s58, s58, 128
s_cmp_eq_u32 s58, 1280
s_cselect_b32 s58, 0, s58
s_lshl_b32 s44, s34, 5
s_lshl_b32 s45, s32, 2
s_add_u32 s44, s44, s45
s_mul_i32 s44, s44, 1280
s_mul_i32 s45, s33, 327680
s_add_u32 s44, s44, s45
s_add_u32 s88, s4, s44
s_addc_u32 s89, s5, 0
s_add_u32 s87, s84, 3
s_cmp_ge_u32 s87, 10
s_cselect_b32 s45, 10, 0
s_sub_u32 s87, s87, s45
s_lshl_b32 s87, s87, 7
s_mov_b32 s47, 65536
s_mov_b32 s55, 49152
s_mov_b32 s39, 0
L_ldloop:
s_add_u32 m0, s42, s55
s_mov_b32 exec_hi, 0x0fffffff
buffer_load_dwordx4 v12, s[24:27], s38 offen offset:0  lds
buffer_load_dwordx4 v13, s[24:27], s38 offen offset:960  lds
buffer_load_dwordx4 v14, s[24:27], s38 offen offset:1920  lds
buffer_load_dwordx4 v15, s[24:27], s38 offen offset:2880  lds
s_mov_b32 exec_hi, -1
s_add_u32 s38, s38, 40960
s_cmp_eq_u32 s38, 819200
s_cselect_b32 s38, 0, s38
s_add_u32 s55, s55, 16384
s_and_b32 s55, s55, 65535
s_add_u32 m0, s40, s47
s_add_u32 s56, s37, s58
buffer_load_dwordx4 v8, s[20:23], s56 offen offset:0  lds
buffer_load_dwordx4 v9, s[20:23], s56 offen offset:1024  lds
buffer_load_dwordx4 v10, s[20:23], s56 offen offset:2048  lds
buffer_load_dwordx4 v11, s[20:23], s56 offen offset:3072  lds
s_cmp_lt_u32 s39, 7
s_cbranch_scc0 L_nst0
s_add_u32 s92, s88, s87
s_addc_u32 s93, s89, 0
s_waitcnt lgkmcnt(6)
s_load_dword s90, s[92:93], 0
s_load_dword s90, s[92:93], 64
s_load_dword s90, s[92:93], 1280
s_load_dword s90, s[92:93], 1344
s_load_dword s90, s[92:93], 2560
s_load_dword s90, s[92:93], 2624
s_load_dword s90, s[92:93], 3840
s_load_dword s90, s[92:93], 3904
L_nst0:
s_waitcnt vmcnt(8)
s_barrier
s_add_u32 m0, s42, s55
s_mov_b32 exec_hi, 0x0fffffff
buffer_load_dwordx4 v12, s[24:27], s38 offen offset:0  lds
buffer_load_dwordx4 v13, s[24:27], s38 offen offset:960  lds
buffer_load_dwordx4 v14, s[24:27], s38 offen offset:1920  lds
buffer_load_dwordx4 v15, s[24:27], s38 offen offset:2880  lds
s_mov_b32 exec_hi, -1
s_add_u32 s38, s38, 40960
s_cmp_eq_u32 s38, 819200
s_cselect_b32 s38, 0, s38
s_add_u32 s55, s55, 16384
s_add_u32 m0, s41, s47
s_add_u32 s56, s59, s58
buffer_load_dwordx4 v8, s[20:23], s56 offen offset:0  lds
buffer_load_dwordx4 v9, s[20:23], s56 offen offset:1024  lds
buffer_load_dwordx4 v10, s[20:23], s56 offen offset:2048  lds
buffer_load_dwordx4 v11, s[20:23], s56 offen offset:3072  lds
s_add_u32 s58, s58, 128
s_cmp_eq_u32 s58, 1280
s_cselect_b32 s58, 0, s58
s_add_u32 s47, s47, 32768
s_cmp_eq_u32 s47, 98304
s_cselect_b32 s47, 0, s47
s_cmp_lt_u32 s39, 7
s_cbranch_scc0 L_nst1
s_add_u32 s92, s88, s87
s_addc_u32 s93, s89, 0
s_waitcnt lgkmcnt(6)
s_load_dword s90, s[92:93], 20480
s_load_dword s90, s[92:93], 20544
s_load_dword s90, s[92:93], 21760
s_load_dword s90, s[92:93], 21824
s_load_dword s90, s[92:93], 23040
s_load_dword s90, s[92:93], 23104
s_load_dword s90, s[92:93], 24320
s_load_dword s90, s[92:93], 24384
s_add_u32 s87, s87, 128
s_cmp_eq_u32 s87, 1280
s_cselect_b32 s87, 0, s87
L_nst1:
s_add_u32 s39, s39, 1
s_cmp_lt_u32 s39, 8
s_waitcnt vmcnt(8)
s_barrier
s_cbranch_scc1 L_ldloop
s_add_u32 m0, s42, s55
s_mov_b32 exec_hi, 0x0fffffff
buffer_load_dwordx4 v12, s[24:27], s38 offen offset:0  lds
buffer_load_dwordx4 v13, s[24:27], s38 offen offset:960  lds
buffer_load_dwordx4 v14, s[24:27], s38 offen offset:1920  lds
buffer_load_dwordx4 v15, s[24:27], s38 offen offset:2880  lds
s_mov_b32 exec_hi, -1
s_add_u32 s38, s38, 40960
s_cmp_eq_u32 s38, 819200
s_cselect_b32 s38, 0, s38
s_waitcnt vmcnt(4)
s_barrier
s_waitcnt vmcnt(0)
s_barrier
s_endpgm
L_compute:
s_lshr_b32 s35, s32, 1
s_and_b32 s36, s32, 1
v_lshrrev_b32 v10, 4, v0
v_and_b32 v11, 15, v0
v_lshrrev_b32 v1, 1, v11
v_xor_b32 v1, v1, v10
v_lshlrev_b32 v1, 4, v1
v_lshl_add_u32 v1, v11, 7, v1
s_lshl_b32 s45, s35, 11
s_add_u32 s45, s45, 65536
v_add_u32 v2, s45, v1
v_xor_b32 v3, 64, v2
v_lshrrev_b32 v1, 1, v10
v_lshlrev_b32 v1, 4, v1
v_and_b32 v4, 1, v10
v_lshl_add_u32 v1, v4, 2, v1
v_bfe_u32 v4, v0, 2, 2
v_add_u32 v1, v1, v4
v_mul_u32_u24 v1, 160, v1
v_and_b32 v4, 3, v0
v_lshl_add_u32 v1, v4, 3, v1
v_add_u32 v5, 16384, v1
v_add_u32 v6, 32768, v1
v_mov_b32 v8, v1
v_mov_b32 v12, 0
v_mov_b32 v13, 0
v_mov_b32 v14, 0
v_mov_b32 v15, 0
v_mov_b32 v16, 0
v_mov_b32 v17, 0
v_mov_b32 v18, 0
v_mov_b32 v19, 0
v_mov_b32 v20, 0
v_mov_b32 v21, 0
v_mov_b32 v22, 0
v_mov_b32 v23, 0
v_mov_b32 v24, 0
v_mov_b32 v25, 0
v_mov_b32 v26, 0
v_mov_b32 v27, 0
v_mov_b32 v28, 0
v_mov_b32 v29, 0
v_mov_b32 v30, 0
v_mov_b32 v31, 0
v_mov_b32 v32, 0
v_mov_b32 v33, 0
v_mov_b32 v34, 0
v_mov_b32 v35, 0
v_mov_b32 v36, 0
v_mov_b32 v37, 0
v_mov_b32 v38, 0
v_mov_b32 v39, 0
v_mov_b32 v40, 0
v_mov_b32 v41, 0
v_mov_b32 v42, 0
v_mov_b32 v43, 0
v_mov_b32 v44, 0
v_mov_b32 v45, 0
v_mov_b32 v46, 0
v_mov_b32 v47, 0
v_mov_b32 v48, 0
v_mov_b32 v49, 0
v_mov_b32 v50, 0
v_mov_b32 v51, 0
v_mov_b32 v52, 0
v_mov_b32 v53, 0
v_mov_b32 v54, 0
v_mov_b32 v55, 0
v_mov_b32 v56, 0
v_mov_b32 v57, 0
v_mov_b32 v58, 0
v_mov_b32 v59, 0
v_mov_b32 v60, 0
v_mov_b32 v61, 0
v_mov_b32 v62, 0
v_mov_b32 v63, 0
v_mov_b32 v64, 0
v_mov_b32 v65, 0
v_mov_b32 v66, 0
v_mov_b32 v67, 0
v_mov_b32 v68, 0
v_mov_b32 v69, 0
v_mov_b32 v70, 0
v_mov_b32 v71, 0
v_mov_b32 v72, 0
v_mov_b32 v73, 0
v_mov_b32 v74, 0
v_mov_b32 v75, 0
v_mov_b32 v76, 0
v_mov_b32 v77, 0
v_mov_b32 v78, 0
v_mov_b32 v79, 0
v_mov_b32 v80, 0
v_mov_b32 v81, 0
v_mov_b32 v82, 0
v_mov_b32 v83, 0
v_mov_b32 v84, 0
v_mov_b32 v85, 0
v_mov_b32 v86, 0
v_mov_b32 v87, 0
v_mov_b32 v88, 0
v_mov_b32 v89, 0
v_mov_b32 v90, 0
v_mov_b32 v91, 0
v_lshlrev_b32 v9, 4, v10
v_add_u32 v9, 15424, v9
s_cmp_eq_u32 s32, 0
s_cbranch_scc0 L_noparam2
s_mov_b32 exec_hi, 0xff
s_mov_b32 s52, 0xbfb8aa3b
s_waitcnt vmcnt(0)
v_lshlrev_b32 v96, 16, v93
v_add_f32 v96, 0x3727c5ac, v96
v_rsq_f32 v96, v96
v_lshlrev_b32 v97, 16, v94
v_lshlrev_b32 v98, 16, v92
v_lshlrev_b32 v99, 16, v95
v_mul_f32 v96, v96, v97
v_fma_f32 v99, -v98, v96, v99
v_mul_f32 v100, s52, v96
v_mul_f32 v102, s52, v99
v_and_b32 v96, 0xffff0000, v93
v_add_f32 v96, 0x3727c5ac, v96
v_rsq_f32 v96, v96
v_and_b32 v97, 0xffff0000, v94
v_and_b32 v98, 0xffff0000, v92
v_and_b32 v99, 0xffff0000, v95
v_mul_f32 v96, v96, v97
v_fma_f32 v99, -v98, v96, v99
v_mul_f32 v101, s52, v96
v_mul_f32 v103, s52, v99
v_lshlrev_b32 v1, 3, v0
v_add_u32 v1, 15424, v1
ds_write_b64 v1, v[100:101]
ds_write_b64 v1, v[102:103] offset:320
s_mov_b64 exec, -1
L_noparam2:
s_waitcnt lgkmcnt(0)
s_mov_b32 s28, s16
s_mov_b32 s29, s17
s_mov_b32 s30, 10485760
s_mov_b32 s31, 0x20000
s_mov_b32 s52, 0x3fb8aa3b
s_mov_b32 s53, 0x3fb8aa3b
s_cmp_eq_u32 s36, 1
s_cbranch_scc1 L_dh1
s_barrier
v_mov_b32 v4, v2
ds_read_b128 a[0:3], v4 offset:0
ds_read_b128 a[4:7], v4 offset:4096
ds_read_b128 a[8:11], v4 offset:8192
ds_read_b128 a[12:15], v4 offset:12288
ds_read_b128 a[16:19], v4 offset:16384
ds_read_b128 a[20:23], v4 offset:20480
ds_read_b128 a[24:27], v4 offset:24576
ds_read_b128 a[28:31], v4 offset:28672
ds_read_b64_tr_b16 a[32:33], v8 offset:0
ds_read_b64_tr_b16 a[34:35], v8 offset:1280
s_waitcnt lgkmcnt(4)
ds_read_b64_tr_b16 a[36:37], v8 offset:5120
ds_read_b64_tr_b16 a[38:39], v8 offset:6400
ds_read_b64_tr_b16 a[40:41], v8 offset:10240
ds_read_b64_tr_b16 a[42:43], v8 offset:11520
ds_read_b64_tr_b16 a[44:45], v8 offset:32
ds_read_b64_tr_b16 a[46:47], v8 offset:1312
ds_read_b64_tr_b16 a[48:49], v8 offset:5152
ds_read_b64_tr_b16 a[50:51], v8 offset:6432
ds_read_b64_tr_b16 a[52:53], v8 offset:10272
ds_read_b64_tr_b16 a[54:55], v8 offset:11552
s_waitcnt lgkmcnt(4)
ds_read_b64_tr_b16 a[56:57], v8 offset:128
ds_read_b64_tr_b16 a[58:59], v8 offset:1408
ds_read_b64_tr_b16 a[60:61], v8 offset:5248
ds_read_b64_tr_b16 a[62:63], v8 offset:6528
ds_read_b64_tr_b16 a[64:65], v8 offset:10368
ds_read_b64_tr_b16 a[66:67], v8 offset:11648
s_lshl_b32 s45, s35, 4
v_add_u32 v1, s45, v11
v_mul_u32_u24 v1, 10240, v1
v_lshrrev_b32 v4, 1, v10
v_lshl_add_u32 v1, v4, 4, v1
v_and_b32 v4, 1, v10
v_lshl_add_u32 v7, v4, 5, v1
v_mul_u32_u24 v4, 1280, v4
v_add_u32 v8, v1, v4
s_mul_i32 s44, s33, 327680
s_lshl_b32 s45, s34, 5
s_add_u32 s43, s44, s45
s_add_u32 s43, s43, 1024
s_lshl_b32 s45, s34, 7
s_add_u32 s44, s44, s45
s_waitcnt lgkmcnt(0)
s_barrier
s_mov_b32 s39, 0
s_mov_b32 s47, 0
L_loop0:
v_mfma_f32_16x16x32_bf16 v[12:15], a[36:39], a[0:3], v[12:15]
v_add_u32 v4, s47, v3
v_mfma_f32_16x16x32_bf16 v[12:15], a[40:43], a[4:7], v[12:15]
ds_read_b128 a[68:71], v4 offset:0
v_mfma_f32_16x16x32_bf16 v[16:19], a[40:43], a[8:11], v[16:19]
ds_read_b128 a[72:75], v4 offset:4096
v_mfma_f32_16x16x32_bf16 v[16:19], a[36:39], a[4:7], v[16:19]
ds_read_b128 a[76:79], v4 offset:8192
v_mfma_f32_16x16x32_bf16 v[16:19], a[32:35], a[0:3], v[16:19]
ds_read_b128 a[80:83], v4 offset:12288
v_mfma_f32_16x16x32_bf16 v[20:23], a[32:35], a[4:7], v[20:23]
ds_read_b128 a[84:87], v4 offset:16384
v_mfma_f32_16x16x32_bf16 v[20:23], a[36:39], a[8:11], v[20:23]
ds_read_b128 a[88:91], v4 offset:20480
v_mfma_f32_16x16x32_bf16 v[20:23], a[40:43], a[12:15], v[20:23]
ds_read_b128 a[92:95], v4 offset:24576
v_mfma_f32_16x16x32_bf16 v[24:27], a[40:43], a[16:19], v[24:27]
ds_read_b128 a[96:99], v4 offset:28672
v_mfma_f32_16x16x32_bf16 v[24:27], a[36:39], a[12:15], v[24:27]
ds_read_b64_tr_b16 v[92:93], v5 offset:0
v_mfma_f32_16x16x32_bf16 v[24:27], a[32:35], a[8:11], v[24:27]
ds_read_b64_tr_b16 v[94:95], v5 offset:1280
v_mfma_f32_16x16x32_bf16 v[28:31], a[32:35], a[12:15], v[28:31]
ds_read_b64_tr_b16 v[96:97], v5 offset:5120
v_mfma_f32_16x16x32_bf16 v[28:31], a[36:39], a[16:19], v[28:31]
ds_read_b64_tr_b16 v[98:99], v5 offset:6400
v_mfma_f32_16x16x32_bf16 v[28:31], a[40:43], a[20:23], v[28:31]
ds_read_b64_tr_b16 v[100:101], v5 offset:10240
v_mfma_f32_16x16x32_bf16 v[32:35], a[40:43], a[24:27], v[32:35]
ds_read_b64_tr_b16 v[102:103], v5 offset:11520
v_mfma_f32_16x16x32_bf16 v[32:35], a[36:39], a[20:23], v[32:35]
ds_read_b64_tr_b16 v[104:105], v5 offset:32
v_mfma_f32_16x16x32_bf16 v[32:35], a[32:35], a[16:19], v[32:35]
ds_read_b64_tr_b16 v[106:107], v5 offset:1312
v_mfma_f32_16x16x32_bf16 v[36:39], a[32:35], a[20:23], v[36:39]
ds_read_b64_tr_b16 v[108:109], v5 offset:5152
v_mfma_f32_16x16x32_bf16 v[36:39], a[36:39], a[24:27], v[36:39]
ds_read_b64_tr_b16 v[110:111], v5 offset:6432
v_mfma_f32_16x16x32_bf16 v[36:39], a[40:43], a[28:31], v[36:39]
ds_read_b64_tr_b16 v[112:113], v5 offset:10272
v_mfma_f32_16x16x32_bf16 v[40:43], a[36:39], a[28:31], v[40:43]
ds_read_b64_tr_b16 v[114:115], v5 offset:11552
v_mfma_f32_16x16x32_bf16 v[40:43], a[32:35], a[24:27], v[40:43]
ds_read_b64_tr_b16 v[116:117], v5 offset:128
v_mfma_f32_16x16x32_bf16 v[44:47], a[48:51], a[0:3], v[44:47]
ds_read_b64_tr_b16 v[118:119], v5 offset:1408
v_mfma_f32_16x16x32_bf16 v[44:47], a[52:55], a[4:7], v[44:47]
ds_read_b64_tr_b16 v[120:121], v5 offset:5248
v_mfma_f32_16x16x32_bf16 v[48:51], a[52:55], a[8:11], v[48:51]
ds_read_b64_tr_b16 v[122:123], v5 offset:6528
v_mfma_f32_16x16x32_bf16 v[48:51], a[48:51], a[4:7], v[48:51]
ds_read_b64_tr_b16 v[124:125], v5 offset:10368
v_mfma_f32_16x16x32_bf16 v[48:51], a[44:47], a[0:3], v[48:51]
ds_read_b64_tr_b16 v[126:127], v5 offset:11648
v_mfma_f32_16x16x32_bf16 v[52:55], a[44:47], a[4:7], v[52:55]
v_mfma_f32_16x16x32_bf16 v[52:55], a[48:51], a[8:11], v[52:55]
v_mfma_f32_16x16x32_bf16 v[52:55], a[52:55], a[12:15], v[52:55]
v_mfma_f32_16x16x32_bf16 v[56:59], a[52:55], a[16:19], v[56:59]
v_mfma_f32_16x16x32_bf16 v[56:59], a[48:51], a[12:15], v[56:59]
v_mfma_f32_16x16x32_bf16 v[56:59], a[44:47], a[8:11], v[56:59]
v_mfma_f32_16x16x32_bf16 v[60:63], a[44:47], a[12:15], v[60:63]
v_mfma_f32_16x16x32_bf16 v[60:63], a[48:51], a[16:19], v[60:63]
v_xor_b32 v5, 0x8000, v5
v_mfma_f32_16x16x32_bf16 v[60:63], a[52:55], a[20:23], v[60:63]
s_add_u32 s47, s47, 32768
v_mfma_f32_16x16x32_bf16 v[64:67], a[52:55], a[24:27], v[64:67]
s_cmp_eq_u32 s47, 98304
v_mfma_f32_16x16x32_bf16 v[64:67], a[48:51], a[20:23], v[64:67]
s_cselect_b32 s47, 0, s47
v_mfma_f32_16x16x32_bf16 v[64:67], a[44:47], a[16:19], v[64:67]
v_mfma_f32_16x16x32_bf16 v[68:71], a[44:47], a[20:23], v[68:71]
v_mfma_f32_16x16x32_bf16 v[68:71], a[48:51], a[24:27], v[68:71]
v_mfma_f32_16x16x32_bf16 v[68:71], a[52:55], a[28:31], v[68:71]
v_mfma_f32_16x16x32_bf16 v[72:75], a[48:51], a[28:31], v[72:75]
v_mfma_f32_16x16x32_bf16 v[72:75], a[44:47], a[24:27], v[72:75]
v_mfma_f32_16x16x32_bf16 v[76:79], a[60:63], a[0:3], v[76:79]
v_mfma_f32_16x16x32_bf16 v[76:79], a[64:67], a[4:7], v[76:79]
v_mfma_f32_16x16x32_bf16 v[80:83], a[64:67], a[8:11], v[80:83]
v_mfma_f32_16x16x32_bf16 v[80:83], a[60:63], a[4:7], v[80:83]
v_mfma_f32_16x16x32_bf16 v[80:83], a[56:59], a[0:3], v[80:83]
v_mfma_f32_16x16x32_bf16 v[84:87], a[56:59], a[4:7], v[84:87]
v_mfma_f32_16x16x32_bf16 v[84:87], a[60:63], a[8:11], v[84:87]
s_waitcnt lgkmcnt(0)
v_mfma_f32_16x16x32_bf16 v[84:87], a[64:67], a[12:15], v[84:87]
v_mfma_f32_16x16x32_bf16 v[88:91], a[64:67], a[16:19], v[88:91]
v_mfma_f32_16x16x32_bf16 v[88:91], a[60:63], a[12:15], v[88:91]
s_barrier
v_mfma_f32_16x16x32_bf16 v[88:91], a[56:59], a[8:11], v[88:91]
v_mfma_f32_16x16x32_bf16 v[12:15], v[96:99], a[68:71], v[12:15]
v_add_u32 v4, s47, v2
v_mfma_f32_16x16x32_bf16 v[12:15], v[100:103], a[72:75], v[12:15]
ds_read_b128 a[0:3], v4 offset:0
v_mfma_f32_16x16x32_bf16 v[16:19], v[100:103], a[76:79], v[16:19]
ds_read_b128 a[4:7], v4 offset:4096
v_mfma_f32_16x16x32_bf16 v[16:19], v[96:99], a[72:75], v[16:19]
ds_read_b128 a[8:11], v4 offset:8192
v_mfma_f32_16x16x32_bf16 v[16:19], v[92:95], a[68:71], v[16:19]
ds_read_b128 a[12:15], v4 offset:12288
v_mfma_f32_16x16x32_bf16 v[20:23], v[92:95], a[72:75], v[20:23]
ds_read_b128 a[16:19], v4 offset:16384
v_mfma_f32_16x16x32_bf16 v[20:23], v[96:99], a[76:79], v[20:23]
ds_read_b128 a[20:23], v4 offset:20480
v_mfma_f32_16x16x32_bf16 v[20:23], v[100:103], a[80:83], v[20:23]
ds_read_b128 a[24:27], v4 offset:24576
v_mfma_f32_16x16x32_bf16 v[24:27], v[100:103], a[84:87], v[24:27]
ds_read_b128 a[28:31], v4 offset:28672
v_mfma_f32_16x16x32_bf16 v[24:27], v[96:99], a[80:83], v[24:27]
ds_read_b64_tr_b16 a[32:33], v6 offset:0
v_mfma_f32_16x16x32_bf16 v[24:27], v[92:95], a[76:79], v[24:27]
ds_read_b64_tr_b16 a[34:35], v6 offset:1280
v_mfma_f32_16x16x32_bf16 v[28:31], v[92:95], a[80:83], v[28:31]
ds_read_b64_tr_b16 a[36:37], v6 offset:5120
v_mfma_f32_16x16x32_bf16 v[28:31], v[96:99], a[84:87], v[28:31]
ds_read_b64_tr_b16 a[38:39], v6 offset:6400
v_mfma_f32_16x16x32_bf16 v[28:31], v[100:103], a[88:91], v[28:31]
ds_read_b64_tr_b16 a[40:41], v6 offset:10240
v_mfma_f32_16x16x32_bf16 v[32:35], v[100:103], a[92:95], v[32:35]
ds_read_b64_tr_b16 a[42:43], v6 offset:11520
v_mfma_f32_16x16x32_bf16 v[32:35], v[96:99], a[88:91], v[32:35]
ds_read_b64_tr_b16 a[44:45], v6 offset:32
v_mfma_f32_16x16x32_bf16 v[32:35], v[92:95], a[84:87], v[32:35]
ds_read_b64_tr_b16 a[46:47], v6 offset:1312
v_mfma_f32_16x16x32_bf16 v[36:39], v[92:95], a[88:91], v[36:39]
ds_read_b64_tr_b16 a[48:49], v6 offset:5152
v_mfma_f32_16x16x32_bf16 v[36:39], v[96:99], a[92:95], v[36:39]
ds_read_b64_tr_b16 a[50:51], v6 offset:6432
v_mfma_f32_16x16x32_bf16 v[36:39], v[100:103], a[96:99], v[36:39]
ds_read_b64_tr_b16 a[52:53], v6 offset:10272
v_mfma_f32_16x16x32_bf16 v[40:43], v[96:99], a[96:99], v[40:43]
ds_read_b64_tr_b16 a[54:55], v6 offset:11552
v_mfma_f32_16x16x32_bf16 v[40:43], v[92:95], a[92:95], v[40:43]
ds_read_b64_tr_b16 a[56:57], v6 offset:128
v_mfma_f32_16x16x32_bf16 v[44:47], v[108:111], a[68:71], v[44:47]
ds_read_b64_tr_b16 a[58:59], v6 offset:1408
v_mfma_f32_16x16x32_bf16 v[44:47], v[112:115], a[72:75], v[44:47]
ds_read_b64_tr_b16 a[60:61], v6 offset:5248
v_mfma_f32_16x16x32_bf16 v[48:51], v[112:115], a[76:79], v[48:51]
ds_read_b64_tr_b16 a[62:63], v6 offset:6528
v_mfma_f32_16x16x32_bf16 v[48:51], v[108:111], a[72:75], v[48:51]
ds_read_b64_tr_b16 a[64:65], v6 offset:10368
v_mfma_f32_16x16x32_bf16 v[48:51], v[104:107], a[68:71], v[48:51]
ds_read_b64_tr_b16 a[66:67], v6 offset:11648
v_mfma_f32_16x16x32_bf16 v[52:55], v[104:107], a[72:75], v[52:55]
v_mfma_f32_16x16x32_bf16 v[52:55], v[108:111], a[76:79], v[52:55]
v_mfma_f32_16x16x32_bf16 v[52:55], v[112:115], a[80:83], v[52:55]
v_mfma_f32_16x16x32_bf16 v[56:59], v[112:115], a[84:87], v[56:59]
v_mfma_f32_16x16x32_bf16 v[56:59], v[108:111], a[80:83], v[56:59]
v_mfma_f32_16x16x32_bf16 v[56:59], v[104:107], a[76:79], v[56:59]
v_mfma_f32_16x16x32_bf16 v[60:63], v[104:107], a[80:83], v[60:63]
v_mfma_f32_16x16x32_bf16 v[60:63], v[108:111], a[84:87], v[60:63]
v_xor_b32 v6, 0x8000, v6
v_mfma_f32_16x16x32_bf16 v[60:63], v[112:115], a[88:91], v[60:63]
s_add_u32 s39, s39, 1
v_mfma_f32_16x16x32_bf16 v[64:67], v[112:115], a[92:95], v[64:67]
s_cmp_lt_u32 s39, 9
v_mfma_f32_16x16x32_bf16 v[64:67], v[108:111], a[88:91], v[64:67]
v_mfma_f32_16x16x32_bf16 v[64:67], v[104:107], a[84:87], v[64:67]
v_mfma_f32_16x16x32_bf16 v[68:71], v[104:107], a[88:91], v[68:71]
v_mfma_f32_16x16x32_bf16 v[68:71], v[108:111], a[92:95], v[68:71]
v_mfma_f32_16x16x32_bf16 v[68:71], v[112:115], a[96:99], v[68:71]
v_mfma_f32_16x16x32_bf16 v[72:75], v[108:111], a[96:99], v[72:75]
v_mfma_f32_16x16x32_bf16 v[72:75], v[104:107], a[92:95], v[72:75]
v_mfma_f32_16x16x32_bf16 v[76:79], v[120:123], a[68:71], v[76:79]
v_mfma_f32_16x16x32_bf16 v[76:79], v[124:127], a[72:75], v[76:79]
v_mfma_f32_16x16x32_bf16 v[80:83], v[124:127], a[76:79], v[80:83]
v_mfma_f32_16x16x32_bf16 v[80:83], v[120:123], a[72:75], v[80:83]
v_mfma_f32_16x16x32_bf16 v[80:83], v[116:119], a[68:71], v[80:83]
v_mfma_f32_16x16x32_bf16 v[84:87], v[116:119], a[72:75], v[84:87]
v_mfma_f32_16x16x32_bf16 v[84:87], v[120:123], a[76:79], v[84:87]
s_waitcnt lgkmcnt(0)
v_mfma_f32_16x16x32_bf16 v[84:87], v[124:127], a[80:83], v[84:87]
v_mfma_f32_16x16x32_bf16 v[88:91], v[124:127], a[84:87], v[88:91]
v_mfma_f32_16x16x32_bf16 v[88:91], v[120:123], a[80:83], v[88:91]
s_barrier
v_mfma_f32_16x16x32_bf16 v[88:91], v[116:119], a[76:79], v[88:91]
s_cbranch_scc1 L_loop0
v_add_u32 v4, s47, v3
v_mfma_f32_16x16x32_bf16 v[12:15], a[36:39], a[0:3], v[12:15]
ds_read_b128 a[68:71], v4 offset:0
ds_read_b64_tr_b16 v[96:97], v5 offset:5120
v_mfma_f32_16x16x32_bf16 v[12:15], a[40:43], a[4:7], v[12:15]
ds_read_b64_tr_b16 v[98:99], v5 offset:6400
ds_read_b64_tr_b16 v[108:109], v5 offset:5152
v_mfma_f32_16x16x32_bf16 v[44:47], a[48:51], a[0:3], v[44:47]
ds_read_b64_tr_b16 v[110:111], v5 offset:6432
ds_read_b128 a[72:75], v4 offset:4096
v_mfma_f32_16x16x32_bf16 v[44:47], a[52:55], a[4:7], v[44:47]
ds_read_b64_tr_b16 v[100:101], v5 offset:10240
ds_read_b64_tr_b16 v[102:103], v5 offset:11520
v_mfma_f32_16x16x32_bf16 v[16:19], a[40:43], a[8:11], v[16:19]
ds_read_b64_tr_b16 v[112:113], v5 offset:10272
ds_read_b64_tr_b16 v[114:115], v5 offset:11552
v_mfma_f32_16x16x32_bf16 v[16:19], a[36:39], a[4:7], v[16:19]
ds_read_b128 v[130:133], v9 offset:0
ds_read_b128 v[138:141], v9 offset:320
v_mfma_f32_16x16x32_bf16 v[16:19], a[32:35], a[0:3], v[16:19]
ds_read_b128 v[134:137], v9 offset:64
ds_read_b128 v[142:145], v9 offset:384
v_mfma_f32_16x16x32_bf16 v[48:51], a[52:55], a[8:11], v[48:51]
ds_read_b64_tr_b16 v[92:93], v5 offset:0
v_mfma_f32_16x16x32_bf16 v[48:51], a[48:51], a[4:7], v[48:51]
v_mfma_f32_16x16x32_bf16 v[48:51], a[44:47], a[0:3], v[48:51]
v_mfma_f32_16x16x32_bf16 v[20:23], a[32:35], a[4:7], v[20:23]
v_mfma_f32_16x16x32_bf16 v[20:23], a[36:39], a[8:11], v[20:23]
s_waitcnt lgkmcnt(1)
v_mfma_f32_16x16x32_bf16 v[12:15], v[96:99], a[68:71], v[12:15]
ds_read_b64_tr_b16 v[94:95], v5 offset:1280
ds_read_b128 a[76:79], v4 offset:8192
v_mfma_f32_16x16x32_bf16 v[12:15], v[100:103], a[72:75], v[12:15]
ds_read_b64_tr_b16 v[104:105], v5 offset:32
ds_read_b64_tr_b16 v[106:107], v5 offset:1312
v_mfma_f32_16x16x32_bf16 v[44:47], v[108:111], a[68:71], v[44:47]
ds_read_b128 a[80:83], v4 offset:12288
ds_read_b128 a[84:87], v4 offset:16384
v_mfma_f32_16x16x32_bf16 v[44:47], v[112:115], a[72:75], v[44:47]
ds_read_b128 a[88:91], v4 offset:20480
ds_read_b128 a[92:95], v4 offset:24576
v_mfma_f32_16x16x32_bf16 v[20:23], a[40:43], a[12:15], v[20:23]
ds_read_b128 a[96:99], v4 offset:28672
ds_read_b64_tr_b16 v[116:117], v5 offset:128
v_mfma_f32_16x16x32_bf16 v[52:55], a[44:47], a[4:7], v[52:55]
ds_read_b64_tr_b16 v[118:119], v5 offset:1408
ds_read_b64_tr_b16 v[120:121], v5 offset:5248
v_mfma_f32_16x16x32_bf16 v[52:55], a[48:51], a[8:11], v[52:55]
ds_read_b64_tr_b16 v[122:123], v5 offset:6528
ds_read_b64_tr_b16 v[124:125], v5 offset:10368
v_mfma_f32_16x16x32_bf16 v[52:55], a[52:55], a[12:15], v[52:55]
ds_read_b64_tr_b16 v[126:127], v5 offset:11648
v_mfma_f32_16x16x32_bf16 v[24:27], a[40:43], a[16:19], v[24:27]
v_mfma_f32_16x16x32_bf16 v[24:27], a[36:39], a[12:15], v[24:27]
v_pk_fma_f32 v[12:13], v[12:13], v[130:131], v[138:139]
v_pk_fma_f32 v[14:15], v[14:15], v[132:133], v[140:141]
v_pk_fma_f32 v[44:45], v[44:45], v[134:135], v[142:143]
v_pk_fma_f32 v[46:47], v[46:47], v[136:137], v[144:145]
v_mfma_f32_16x16x32_bf16 v[24:27], a[32:35], a[8:11], v[24:27]
v_exp_f32 v146, v12
v_mfma_f32_16x16x32_bf16 v[56:59], a[52:55], a[16:19], v[56:59]
v_exp_f32 v147, v13
v_mfma_f32_16x16x32_bf16 v[56:59], a[48:51], a[12:15], v[56:59]
v_exp_f32 v148, v14
v_mfma_f32_16x16x32_bf16 v[56:59], a[44:47], a[8:11], v[56:59]
v_exp_f32 v149, v15
s_waitcnt lgkmcnt(0)
v_mfma_f32_16x16x32_bf16 v[16:19], v[100:103], a[76:79], v[16:19]
v_exp_f32 v150, v44
v_exp_f32 v151, v45
v_exp_f32 v152, v46
v_exp_f32 v153, v47
v_pk_fma_f32 v[146:147], v[146:147], s[52:53], s[52:53]
v_pk_fma_f32 v[148:149], v[148:149], s[52:53], s[52:53]
v_pk_fma_f32 v[150:151], v[150:151], s[52:53], s[52:53]
v_pk_fma_f32 v[152:153], v[152:153], s[52:53], s[52:53]
v_mfma_f32_16x16x32_bf16 v[16:19], v[96:99], a[72:75], v[16:19]
v_rcp_f32 v146, v146
v_mfma_f32_16x16x32_bf16 v[16:19], v[92:95], a[68:71], v[16:19]
v_rcp_f32 v147, v147
v_mfma_f32_16x16x32_bf16 v[48:51], v[112:115], a[76:79], v[48:51]
v_rcp_f32 v148, v148
v_mfma_f32_16x16x32_bf16 v[48:51], v[108:111], a[72:75], v[48:51]
v_rcp_f32 v149, v149
v_mfma_f32_16x16x32_bf16 v[48:51], v[104:107], a[68:71], v[48:51]
v_rcp_f32 v150, v150
v_rcp_f32 v151, v151
v_rcp_f32 v152, v152
v_rcp_f32 v153, v153
s_add_u32 s45, s44, 0
v_pk_mul_f32 v[12:13], v[12:13], v[146:147] neg_lo:[1,0] neg_hi:[1,0]
v_pk_mul_f32 v[14:15], v[14:15], v[148:149] neg_lo:[1,0] neg_hi:[1,0]
v_pk_mul_f32 v[44:45], v[44:45], v[150:151] neg_lo:[1,0] neg_hi:[1,0]
v_pk_mul_f32 v[46:47], v[46:47], v[152:153] neg_lo:[1,0] neg_hi:[1,0]
v_cvt_pk_bf16_f32 v12, v12, v13
v_cvt_pk_bf16_f32 v13, v14, v15
v_cvt_pk_bf16_f32 v14, v44, v45
v_cvt_pk_bf16_f32 v15, v46, v47
v_pk_fma_f32 v[16:17], v[16:17], v[130:131], v[138:139]
v_pk_fma_f32 v[18:19], v[18:19], v[132:133], v[140:141]
v_pk_fma_f32 v[48:49], v[48:49], v[134:135], v[142:143]
v_pk_fma_f32 v[50:51], v[50:51], v[136:137], v[144:145]
v_permlane16_swap_b32 v12, v14
v_permlane16_swap_b32 v13, v15
v_mfma_f32_16x16x32_bf16 v[20:23], v[92:95], a[72:75], v[20:23]
v_exp_f32 v146, v16
v_mfma_f32_16x16x32_bf16 v[20:23], v[96:99], a[76:79], v[20:23]
v_exp_f32 v147, v17
v_mfma_f32_16x16x32_bf16 v[20:23], v[100:103], a[80:83], v[20:23]
v_exp_f32 v148, v18
v_mfma_f32_16x16x32_bf16 v[52:55], v[104:107], a[72:75], v[52:55]
v_exp_f32 v149, v19
v_mfma_f32_16x16x32_bf16 v[52:55], v[108:111], a[76:79], v[52:55]
v_exp_f32 v150, v48
v_exp_f32 v151, v49
buffer_store_dwordx4 v[12:15], v7, s[28:31], s45 offen sc1
v_exp_f32 v152, v50
v_exp_f32 v153, v51
v_pk_fma_f32 v[146:147], v[146:147], s[52:53], s[52:53]
v_pk_fma_f32 v[148:149], v[148:149], s[52:53], s[52:53]
v_pk_fma_f32 v[150:151], v[150:151], s[52:53], s[52:53]
v_pk_fma_f32 v[152:153], v[152:153], s[52:53], s[52:53]
v_mfma_f32_16x16x32_bf16 v[52:55], v[112:115], a[80:83], v[52:55]
v_rcp_f32 v146, v146
v_mfma_f32_16x16x32_bf16 v[28:31], a[32:35], a[12:15], v[28:31]
v_rcp_f32 v147, v147
v_mfma_f32_16x16x32_bf16 v[28:31], a[36:39], a[16:19], v[28:31]
v_rcp_f32 v148, v148
v_mfma_f32_16x16x32_bf16 v[28:31], a[40:43], a[20:23], v[28:31]
v_rcp_f32 v149, v149
v_mfma_f32_16x16x32_bf16 v[60:63], a[44:47], a[12:15], v[60:63]
v_rcp_f32 v150, v150
v_rcp_f32 v151, v151
v_rcp_f32 v152, v152
v_rcp_f32 v153, v153
s_add_u32 s46, s44, 1280
v_pk_mul_f32 v[16:17], v[16:17], v[146:147] neg_lo:[1,0] neg_hi:[1,0]
v_pk_mul_f32 v[18:19], v[18:19], v[148:149] neg_lo:[1,0] neg_hi:[1,0]
v_pk_mul_f32 v[48:49], v[48:49], v[150:151] neg_lo:[1,0] neg_hi:[1,0]
v_pk_mul_f32 v[50:51], v[50:51], v[152:153] neg_lo:[1,0] neg_hi:[1,0]
v_cvt_pk_bf16_f32 v16, v16, v17
v_cvt_pk_bf16_f32 v17, v18, v19
v_cvt_pk_bf16_f32 v18, v48, v49
v_cvt_pk_bf16_f32 v19, v50, v51
v_pk_fma_f32 v[20:21], v[20:21], v[130:131], v[138:139]
v_pk_fma_f32 v[22:23], v[22:23], v[132:133], v[140:141]
v_pk_fma_f32 v[52:53], v[52:53], v[134:135], v[142:143]
v_pk_fma_f32 v[54:55], v[54:55], v[136:137], v[144:145]
v_permlane16_swap_b32 v16, v18
v_permlane16_swap_b32 v17, v19
v_mfma_f32_16x16x32_bf16 v[24:27], v[100:103], a[84:87], v[24:27]
v_exp_f32 v146, v20
v_mfma_f32_16x16x32_bf16 v[24:27], v[96:99], a[80:83], v[24:27]
v_exp_f32 v147, v21
v_mfma_f32_16x16x32_bf16 v[24:27], v[92:95], a[76:79], v[24:27]
v_exp_f32 v148, v22
v_mfma_f32_16x16x32_bf16 v[56:59], v[112:115], a[84:87], v[56:59]
v_exp_f32 v149, v23
v_mfma_f32_16x16x32_bf16 v[56:59], v[108:111], a[80:83], v[56:59]
v_exp_f32 v150, v52
v_exp_f32 v151, v53
buffer_store_dwordx4 v[16:19], v7, s[28:31], s46 offen sc1
v_exp_f32 v152, v54
v_exp_f32 v153, v55
v_pk_fma_f32 v[146:147], v[146:147], s[52:53], s[52:53]
v_pk_fma_f32 v[148:149], v[148:149], s[52:53], s[52:53]
v_pk_fma_f32 v[150:151], v[150:151], s[52:53], s[52:53]
v_pk_fma_f32 v[152:153], v[152:153], s[52:53], s[52:53]
v_mfma_f32_16x16x32_bf16 v[56:59], v[104:107], a[76:79], v[56:59]
v_rcp_f32 v146, v146
v_mfma_f32_16x16x32_bf16 v[60:63], a[48:51], a[16:19], v[60:63]
v_rcp_f32 v147, v147
v_mfma_f32_16x16x32_bf16 v[60:63], a[52:55], a[20:23], v[60:63]
v_rcp_f32 v148, v148
v_mfma_f32_16x16x32_bf16 v[32:35], a[40:43], a[24:27], v[32:35]
v_rcp_f32 v149, v149
v_mfma_f32_16x16x32_bf16 v[32:35], a[36:39], a[20:23], v[32:35]
v_rcp_f32 v150, v150
v_rcp_f32 v151, v151
v_rcp_f32 v152, v152
v_rcp_f32 v153, v153
ds_read_b128 v[44:47], v9 offset:256
ds_read_b128 v[48:51], v9 offset:576
s_add_u32 s45, s44, 2560
v_pk_mul_f32 v[20:21], v[20:21], v[146:147] neg_lo:[1,0] neg_hi:[1,0]
v_pk_mul_f32 v[22:23], v[22:23], v[148:149] neg_lo:[1,0] neg_hi:[1,0]
v_pk_mul_f32 v[52:53], v[52:53], v[150:151] neg_lo:[1,0] neg_hi:[1,0]
v_pk_mul_f32 v[54:55], v[54:55], v[152:153] neg_lo:[1,0] neg_hi:[1,0]
v_cvt_pk_bf16_f32 v20, v20, v21
v_cvt_pk_bf16_f32 v21, v22, v23
v_cvt_pk_bf16_f32 v22, v52, v53
v_cvt_pk_bf16_f32 v23, v54, v55
v_pk_fma_f32 v[24:25], v[24:25], v[130:131], v[138:139]
v_pk_fma_f32 v[26:27], v[26:27], v[132:133], v[140:141]
v_pk_fma_f32 v[56:57], v[56:57], v[134:135], v[142:143]
v_pk_fma_f32 v[58:59], v[58:59], v[136:137], v[144:145]
v_permlane16_swap_b32 v20, v22
v_permlane16_swap_b32 v21, v23
v_mfma_f32_16x16x32_bf16 v[28:31], v[92:95], a[80:83], v[28:31]
v_exp_f32 v146, v24
v_mfma_f32_16x16x32_bf16 v[28:31], v[96:99], a[84:87], v[28:31]
v_exp_f32 v147, v25
v_mfma_f32_16x16x32_bf16 v[28:31], v[100:103], a[88:91], v[28:31]
v_exp_f32 v148, v26
v_mfma_f32_16x16x32_bf16 v[60:63], v[104:107], a[80:83], v[60:63]
v_exp_f32 v149, v27
v_mfma_f32_16x16x32_bf16 v[60:63], v[108:111], a[84:87], v[60:63]
v_exp_f32 v150, v56
v_exp_f32 v151, v57
buffer_store_dwordx4 v[20:23], v7, s[28:31], s45 offen sc1
v_exp_f32 v152, v58
v_exp_f32 v153, v59
v_pk_fma_f32 v[146:147], v[146:147], s[52:53], s[52:53]
v_pk_fma_f32 v[148:149], v[148:149], s[52:53], s[52:53]
v_pk_fma_f32 v[150:151], v[150:151], s[52:53], s[52:53]
v_pk_fma_f32 v[152:153], v[152:153], s[52:53], s[52:53]
v_mfma_f32_16x16x32_bf16 v[60:63], v[112:115], a[88:91], v[60:63]
v_rcp_f32 v146, v146
v_mfma_f32_16x16x32_bf16 v[32:35], a[32:35], a[16:19], v[32:35]
v_rcp_f32 v147, v147
v_mfma_f32_16x16x32_bf16 v[64:67], a[52:55], a[24:27], v[64:67]
v_rcp_f32 v148, v148
v_mfma_f32_16x16x32_bf16 v[64:67], a[48:51], a[20:23], v[64:67]
v_rcp_f32 v149, v149
v_mfma_f32_16x16x32_bf16 v[64:67], a[44:47], a[16:19], v[64:67]
v_rcp_f32 v150, v150
v_rcp_f32 v151, v151
v_rcp_f32 v152, v152
v_rcp_f32 v153, v153
s_add_u32 s46, s44, 3840
v_pk_mul_f32 v[24:25], v[24:25], v[146:147] neg_lo:[1,0] neg_hi:[1,0]
v_pk_mul_f32 v[26:27], v[26:27], v[148:149] neg_lo:[1,0] neg_hi:[1,0]
v_pk_mul_f32 v[56:57], v[56:57], v[150:151] neg_lo:[1,0] neg_hi:[1,0]
v_pk_mul_f32 v[58:59], v[58:59], v[152:153] neg_lo:[1,0] neg_hi:[1,0]
v_cvt_pk_bf16_f32 v24, v24, v25
v_cvt_pk_bf16_f32 v25, v26, v27
v_cvt_pk_bf16_f32 v26, v56, v57
v_cvt_pk_bf16_f32 v27, v58, v59
v_pk_fma_f32 v[28:29], v[28:29], v[130:131], v[138:139]
v_pk_fma_f32 v[30:31], v[30:31], v[132:133], v[140:141]
v_pk_fma_f32 v[60:61], v[60:61], v[134:135], v[142:143]
v_pk_fma_f32 v[62:63], v[62:63], v[136:137], v[144:145]
v_permlane16_swap_b32 v24, v26
v_permlane16_swap_b32 v25, v27
v_mfma_f32_16x16x32_bf16 v[32:35], v[100:103], a[92:95], v[32:35]
v_exp_f32 v146, v28
v_mfma_f32_16x16x32_bf16 v[32:35], v[96:99], a[88:91], v[32:35]
v_exp_f32 v147, v29
v_mfma_f32_16x16x32_bf16 v[32:35], v[92:95], a[84:87], v[32:35]
v_exp_f32 v148, v30
v_mfma_f32_16x16x32_bf16 v[64:67], v[112:115], a[92:95], v[64:67]
v_exp_f32 v149, v31
v_mfma_f32_16x16x32_bf16 v[64:67], v[108:111], a[88:91], v[64:67]
v_exp_f32 v150, v60
v_exp_f32 v151, v61
buffer_store_dwordx4 v[24:27], v7, s[28:31], s46 offen sc1
v_exp_f32 v152, v62
v_exp_f32 v153, v63
v_pk_fma_f32 v[146:147], v[146:147], s[52:53], s[52:53]
v_pk_fma_f32 v[148:149], v[148:149], s[52:53], s[52:53]
v_pk_fma_f32 v[150:151], v[150:151], s[52:53], s[52:53]
v_pk_fma_f32 v[152:153], v[152:153], s[52:53], s[52:53]
v_mfma_f32_16x16x32_bf16 v[64:67], v[104:107], a[84:87], v[64:67]
v_rcp_f32 v146, v146
v_mfma_f32_16x16x32_bf16 v[36:39], a[32:35], a[20:23], v[36:39]
v_rcp_f32 v147, v147
v_mfma_f32_16x16x32_bf16 v[36:39], a[36:39], a[24:27], v[36:39]
v_rcp_f32 v148, v148
v_mfma_f32_16x16x32_bf16 v[36:39], a[40:43], a[28:31], v[36:39]
v_rcp_f32 v149, v149
v_mfma_f32_16x16x32_bf16 v[68:71], a[44:47], a[20:23], v[68:71]
v_rcp_f32 v150, v150
v_rcp_f32 v151, v151
v_rcp_f32 v152, v152
v_rcp_f32 v153, v153
s_add_u32 s45, s44, 5120
v_pk_mul_f32 v[28:29], v[28:29], v[146:147] neg_lo:[1,0] neg_hi:[1,0]
v_pk_mul_f32 v[30:31], v[30:31], v[148:149] neg_lo:[1,0] neg_hi:[1,0]
v_pk_mul_f32 v[60:61], v[60:61], v[150:151] neg_lo:[1,0] neg_hi:[1,0]
v_pk_mul_f32 v[62:63], v[62:63], v[152:153] neg_lo:[1,0] neg_hi:[1,0]
v_cvt_pk_bf16_f32 v28, v28, v29
v_cvt_pk_bf16_f32 v29, v30, v31
v_cvt_pk_bf16_f32 v30, v60, v61
v_cvt_pk_bf16_f32 v31, v62, v63
v_pk_fma_f32 v[32:33], v[32:33], v[130:131], v[138:139]
v_pk_fma_f32 v[34:35], v[34:35], v[132:133], v[140:141]
v_pk_fma_f32 v[64:65], v[64:65], v[134:135], v[142:143]
v_pk_fma_f32 v[66:67], v[66:67], v[136:137], v[144:145]
v_permlane16_swap_b32 v28, v30
v_permlane16_swap_b32 v29, v31
v_mfma_f32_16x16x32_bf16 v[68:71], a[48:51], a[24:27], v[68:71]
v_exp_f32 v146, v32
v_mfma_f32_16x16x32_bf16 v[68:71], a[52:55], a[28:31], v[68:71]
v_exp_f32 v147, v33
v_mfma_f32_16x16x32_bf16 v[36:39], v[92:95], a[88:91], v[36:39]
v_exp_f32 v148, v34
v_mfma_f32_16x16x32_bf16 v[36:39], v[96:99], a[92:95], v[36:39]
v_exp_f32 v149, v35
v_mfma_f32_16x16x32_bf16 v[36:39], v[100:103], a[96:99], v[36:39]
v_exp_f32 v150, v64
v_exp_f32 v151, v65
buffer_store_dwordx4 v[28:31], v7, s[28:31], s45 offen sc1
v_exp_f32 v152, v66
v_exp_f32 v153, v67
v_pk_fma_f32 v[146:147], v[146:147], s[52:53], s[52:53]
v_pk_fma_f32 v[148:149], v[148:149], s[52:53], s[52:53]
v_pk_fma_f32 v[150:151], v[150:151], s[52:53], s[52:53]
v_pk_fma_f32 v[152:153], v[152:153], s[52:53], s[52:53]
v_mfma_f32_16x16x32_bf16 v[68:71], v[104:107], a[88:91], v[68:71]
v_rcp_f32 v146, v146
v_mfma_f32_16x16x32_bf16 v[68:71], v[108:111], a[92:95], v[68:71]
v_rcp_f32 v147, v147
v_mfma_f32_16x16x32_bf16 v[68:71], v[112:115], a[96:99], v[68:71]
v_rcp_f32 v148, v148
v_mfma_f32_16x16x32_bf16 v[40:43], a[36:39], a[28:31], v[40:43]
v_rcp_f32 v149, v149
v_mfma_f32_16x16x32_bf16 v[40:43], a[32:35], a[24:27], v[40:43]
v_rcp_f32 v150, v150
v_rcp_f32 v151, v151
v_rcp_f32 v152, v152
v_rcp_f32 v153, v153
s_add_u32 s46, s44, 6400
v_pk_mul_f32 v[32:33], v[32:33], v[146:147] neg_lo:[1,0] neg_hi:[1,0]
v_pk_mul_f32 v[34:35], v[34:35], v[148:149] neg_lo:[1,0] neg_hi:[1,0]
v_pk_mul_f32 v[64:65], v[64:65], v[150:151] neg_lo:[1,0] neg_hi:[1,0]
v_pk_mul_f32 v[66:67], v[66:67], v[152:153] neg_lo:[1,0] neg_hi:[1,0]
v_cvt_pk_bf16_f32 v32, v32, v33
v_cvt_pk_bf16_f32 v33, v34, v35
v_cvt_pk_bf16_f32 v34, v64, v65
v_cvt_pk_bf16_f32 v35, v66, v67
v_pk_fma_f32 v[36:37], v[36:37], v[130:131], v[138:139]
v_pk_fma_f32 v[38:39], v[38:39], v[132:133], v[140:141]
v_pk_fma_f32 v[68:69], v[68:69], v[134:135], v[142:143]
v_pk_fma_f32 v[70:71], v[70:71], v[136:137], v[144:145]
v_permlane16_swap_b32 v32, v34
v_permlane16_swap_b32 v33, v35
v_mfma_f32_16x16x32_bf16 v[72:75], a[48:51], a[28:31], v[72:75]
v_exp_f32 v146, v36
v_mfma_f32_16x16x32_bf16 v[72:75], a[44:47], a[24:27], v[72:75]
v_exp_f32 v147, v37
v_mfma_f32_16x16x32_bf16 v[40:43], v[96:99], a[96:99], v[40:43]
v_exp_f32 v148, v38
v_mfma_f32_16x16x32_bf16 v[40:43], v[92:95], a[92:95], v[40:43]
v_exp_f32 v149, v39
v_mfma_f32_16x16x32_bf16 v[72:75], v[108:111], a[96:99], v[72:75]
v_exp_f32 v150, v68
v_mfma_f32_16x16x32_bf16 v[72:75], v[104:107], a[92:95], v[72:75]
v_exp_f32 v151, v69
buffer_store_dwordx4 v[32:35], v7, s[28:31], s46 offen sc1
v_exp_f32 v152, v70
v_exp_f32 v153, v71
v_pk_fma_f32 v[146:147], v[146:147], s[52:53], s[52:53]
v_pk_fma_f32 v[148:149], v[148:149], s[52:53], s[52:53]
v_pk_fma_f32 v[150:151], v[150:151], s[52:53], s[52:53]
v_pk_fma_f32 v[152:153], v[152:153], s[52:53], s[52:53]
v_mfma_f32_16x16x32_bf16 v[76:79], a[60:63], a[0:3], v[76:79]
v_rcp_f32 v146, v146
v_mfma_f32_16x16x32_bf16 v[76:79], a[64:67], a[4:7], v[76:79]
v_rcp_f32 v147, v147
v_mfma_f32_16x16x32_bf16 v[80:83], a[64:67], a[8:11], v[80:83]
v_rcp_f32 v148, v148
v_mfma_f32_16x16x32_bf16 v[80:83], a[60:63], a[4:7], v[80:83]
v_rcp_f32 v149, v149
v_mfma_f32_16x16x32_bf16 v[80:83], a[56:59], a[0:3], v[80:83]
v_rcp_f32 v150, v150
v_rcp_f32 v151, v151
v_rcp_f32 v152, v152
v_rcp_f32 v153, v153
s_add_u32 s45, s44, 7680
v_pk_mul_f32 v[36:37], v[36:37], v[146:147] neg_lo:[1,0] neg_hi:[1,0]
v_pk_mul_f32 v[38:39], v[38:39], v[148:149] neg_lo:[1,0] neg_hi:[1,0]
v_pk_mul_f32 v[68:69], v[68:69], v[150:151] neg_lo:[1,0] neg_hi:[1,0]
v_pk_mul_f32 v[70:71], v[70:71], v[152:153] neg_lo:[1,0] neg_hi:[1,0]
v_cvt_pk_bf16_f32 v36, v36, v37
v_cvt_pk_bf16_f32 v37, v38, v39
v_cvt_pk_bf16_f32 v38, v68, v69
v_cvt_pk_bf16_f32 v39, v70, v71
v_pk_fma_f32 v[40:41], v[40:41], v[130:131], v[138:139]
v_pk_fma_f32 v[42:43], v[42:43], v[132:133], v[140:141]
v_pk_fma_f32 v[72:73], v[72:73], v[134:135], v[142:143]
v_pk_fma_f32 v[74:75], v[74:75], v[136:137], v[144:145]
v_permlane16_swap_b32 v36, v38
v_permlane16_swap_b32 v37, v39
v_mfma_f32_16x16x32_bf16 v[76:79], v[120:123], a[68:71], v[76:79]
v_exp_f32 v146, v40
v_mfma_f32_16x16x32_bf16 v[76:79], v[124:127], a[72:75], v[76:79]
v_exp_f32 v147, v41
v_mfma_f32_16x16x32_bf16 v[80:83], v[124:127], a[76:79], v[80:83]
v_exp_f32 v148, v42
v_exp_f32 v149, v43
v_mfma_f32_16x16x32_bf16 v[80:83], v[120:123], a[72:75], v[80:83]
v_exp_f32 v150, v72
v_exp_f32 v151, v73
buffer_store_dwordx4 v[36:39], v7, s[28:31], s45 offen sc1
v_exp_f32 v152, v74
v_exp_f32 v153, v75
v_pk_fma_f32 v[146:147], v[146:147], s[52:53], s[52:53]
v_pk_fma_f32 v[148:149], v[148:149], s[52:53], s[52:53]
v_pk_fma_f32 v[150:151], v[150:151], s[52:53], s[52:53]
v_pk_fma_f32 v[152:153], v[152:153], s[52:53], s[52:53]
v_mfma_f32_16x16x32_bf16 v[80:83], v[116:119], a[68:71], v[80:83]
v_rcp_f32 v146, v146
v_mfma_f32_16x16x32_bf16 v[84:87], a[56:59], a[4:7], v[84:87]
v_rcp_f32 v147, v147
v_mfma_f32_16x16x32_bf16 v[84:87], a[60:63], a[8:11], v[84:87]
v_rcp_f32 v148, v148
v_rcp_f32 v149, v149
v_mfma_f32_16x16x32_bf16 v[84:87], a[64:67], a[12:15], v[84:87]
v_rcp_f32 v150, v150
v_rcp_f32 v151, v151
v_rcp_f32 v152, v152
v_rcp_f32 v153, v153
s_add_u32 s46, s44, 8960
v_pk_mul_f32 v[40:41], v[40:41], v[146:147] neg_lo:[1,0] neg_hi:[1,0]
v_pk_mul_f32 v[42:43], v[42:43], v[148:149] neg_lo:[1,0] neg_hi:[1,0]
v_pk_mul_f32 v[72:73], v[72:73], v[150:151] neg_lo:[1,0] neg_hi:[1,0]
v_pk_mul_f32 v[74:75], v[74:75], v[152:153] neg_lo:[1,0] neg_hi:[1,0]
v_cvt_pk_bf16_f32 v40, v40, v41
v_cvt_pk_bf16_f32 v41, v42, v43
v_cvt_pk_bf16_f32 v42, v72, v73
v_cvt_pk_bf16_f32 v43, v74, v75
s_waitcnt lgkmcnt(0)
v_pk_fma_f32 v[76:77], v[76:77], v[44:45], v[48:49]
v_pk_fma_f32 v[78:79], v[78:79], v[46:47], v[50:51]
v_pk_fma_f32 v[80:81], v[80:81], v[44:45], v[48:49]
v_pk_fma_f32 v[82:83], v[82:83], v[46:47], v[50:51]
v_permlane16_swap_b32 v40, v42
v_permlane16_swap_b32 v41, v43
buffer_store_dwordx4 v[40:43], v7, s[28:31], s46 offen sc1
v_mfma_f32_16x16x32_bf16 v[84:87], v[116:119], a[72:75], v[84:87]
v_exp_f32 v146, v76
v_mfma_f32_16x16x32_bf16 v[84:87], v[120:123], a[76:79], v[84:87]
v_exp_f32 v147, v77
v_mfma_f32_16x16x32_bf16 v[84:87], v[124:127], a[80:83], v[84:87]
v_exp_f32 v148, v78
v_mfma_f32_16x16x32_bf16 v[88:91], a[64:67], a[16:19], v[88:91]
v_exp_f32 v149, v79
v_mfma_f32_16x16x32_bf16 v[88:91], a[60:63], a[12:15], v[88:91]
v_exp_f32 v150, v80
v_exp_f32 v151, v81
v_exp_f32 v152, v82
v_exp_f32 v153, v83
v_pk_fma_f32 v[146:147], v[146:147], s[52:53], s[52:53]
v_pk_fma_f32 v[148:149], v[148:149], s[52:53], s[52:53]
v_pk_fma_f32 v[150:151], v[150:151], s[52:53], s[52:53]
v_pk_fma_f32 v[152:153], v[152:153], s[52:53], s[52:53]
v_mfma_f32_16x16x32_bf16 v[88:91], a[56:59], a[8:11], v[88:91]
v_rcp_f32 v146, v146
v_mfma_f32_16x16x32_bf16 v[88:91], v[124:127], a[84:87], v[88:91]
v_rcp_f32 v147, v147
v_mfma_f32_16x16x32_bf16 v[88:91], v[120:123], a[80:83], v[88:91]
v_rcp_f32 v148, v148
v_rcp_f32 v149, v149
v_mfma_f32_16x16x32_bf16 v[88:91], v[116:119], a[76:79], v[88:91]
v_rcp_f32 v150, v150
v_rcp_f32 v151, v151
v_rcp_f32 v152, v152
v_rcp_f32 v153, v153
s_add_u32 s45, s43, 0
v_pk_mul_f32 v[76:77], v[76:77], v[146:147] neg_lo:[1,0] neg_hi:[1,0]
v_pk_mul_f32 v[78:79], v[78:79], v[148:149] neg_lo:[1,0] neg_hi:[1,0]
v_pk_mul_f32 v[80:81], v[80:81], v[150:151] neg_lo:[1,0] neg_hi:[1,0]
v_pk_mul_f32 v[82:83], v[82:83], v[152:153] neg_lo:[1,0] neg_hi:[1,0]
v_cvt_pk_bf16_f32 v76, v76, v77
v_cvt_pk_bf16_f32 v77, v78, v79
v_cvt_pk_bf16_f32 v78, v80, v81
v_cvt_pk_bf16_f32 v79, v82, v83
v_pk_fma_f32 v[84:85], v[84:85], v[44:45], v[48:49]
v_pk_fma_f32 v[86:87], v[86:87], v[46:47], v[50:51]
v_pk_fma_f32 v[88:89], v[88:89], v[44:45], v[48:49]
v_pk_fma_f32 v[90:91], v[90:91], v[46:47], v[50:51]
v_permlane16_swap_b32 v76, v78
v_permlane16_swap_b32 v77, v79
buffer_store_dwordx4 v[76:79], v8, s[28:31], s45 offen
v_exp_f32 v146, v84
v_exp_f32 v147, v85
v_exp_f32 v148, v86
v_exp_f32 v149, v87
v_exp_f32 v150, v88
v_exp_f32 v151, v89
v_exp_f32 v152, v90
v_exp_f32 v153, v91
v_pk_fma_f32 v[146:147], v[146:147], s[52:53], s[52:53]
v_pk_fma_f32 v[148:149], v[148:149], s[52:53], s[52:53]
v_pk_fma_f32 v[150:151], v[150:151], s[52:53], s[52:53]
v_pk_fma_f32 v[152:153], v[152:153], s[52:53], s[52:53]
v_rcp_f32 v146, v146
v_rcp_f32 v147, v147
v_rcp_f32 v148, v148
v_rcp_f32 v149, v149
v_rcp_f32 v150, v150
v_rcp_f32 v151, v151
v_rcp_f32 v152, v152
v_rcp_f32 v153, v153
s_add_u32 s46, s43, 2560
v_pk_mul_f32 v[84:85], v[84:85], v[146:147] neg_lo:[1,0] neg_hi:[1,0]
v_pk_mul_f32 v[86:87], v[86:87], v[148:149] neg_lo:[1,0] neg_hi:[1,0]
v_pk_mul_f32 v[88:89], v[88:89], v[150:151] neg_lo:[1,0] neg_hi:[1,0]
v_pk_mul_f32 v[90:91], v[90:91], v[152:153] neg_lo:[1,0] neg_hi:[1,0]
v_cvt_pk_bf16_f32 v84, v84, v85
v_cvt_pk_bf16_f32 v85, v86, v87
v_cvt_pk_bf16_f32 v86, v88, v89
v_cvt_pk_bf16_f32 v87, v90, v91
s_nop 1
v_permlane16_swap_b32 v84, v86
v_permlane16_swap_b32 v85, v87
buffer_store_dwordx4 v[84:87], v8, s[28:31], s46 offen
s_endpgm
L_dh1:
s_barrier
v_mov_b32 v4, v2
ds_read_b128 a[0:3], v4 offset:0
ds_read_b128 a[4:7], v4 offset:4096
ds_read_b128 a[8:11], v4 offset:8192
ds_read_b128 a[12:15], v4 offset:12288
ds_read_b128 a[16:19], v4 offset:16384
ds_read_b128 a[20:23], v4 offset:20480
ds_read_b128 a[24:27], v4 offset:24576
ds_read_b128 a[28:31], v4 offset:28672
ds_read_b64_tr_b16 a[32:33], v8 offset:64
ds_read_b64_tr_b16 a[34:35], v8 offset:1344
s_waitcnt lgkmcnt(4)
ds_read_b64_tr_b16 a[36:37], v8 offset:5184
ds_read_b64_tr_b16 a[38:39], v8 offset:6464
ds_read_b64_tr_b16 a[40:41], v8 offset:10304
ds_read_b64_tr_b16 a[42:43], v8 offset:11584
ds_read_b64_tr_b16 a[44:45], v8 offset:96
ds_read_b64_tr_b16 a[46:47], v8 offset:1376
ds_read_b64_tr_b16 a[48:49], v8 offset:5216
ds_read_b64_tr_b16 a[50:51], v8 offset:6496
ds_read_b64_tr_b16 a[52:53], v8 offset:10336
ds_read_b64_tr_b16 a[54:55], v8 offset:11616
s_waitcnt lgkmcnt(4)
ds_read_b64_tr_b16 a[56:57], v8 offset:128
ds_read_b64_tr_b16 a[58:59], v8 offset:1408
ds_read_b64_tr_b16 a[60:61], v8 offset:5248
ds_read_b64_tr_b16 a[62:63], v8 offset:6528
ds_read_b64_tr_b16 a[64:65], v8 offset:10368
ds_read_b64_tr_b16 a[66:67], v8 offset:11648
s_lshl_b32 s45, s35, 4
v_add_u32 v1, s45, v11
v_mul_u32_u24 v1, 10240, v1
v_lshrrev_b32 v4, 1, v10
v_lshl_add_u32 v1, v4, 4, v1
v_and_b32 v4, 1, v10
v_lshl_add_u32 v7, v4, 5, v1
v_add_u32 v7, 64, v7
v_mul_u32_u24 v4, 1280, v4
v_add_u32 v8, v1, v4
s_mul_i32 s44, s33, 327680
s_lshl_b32 s45, s34, 5
s_add_u32 s43, s44, s45
s_add_u32 s43, s43, 1024
s_lshl_b32 s45, s34, 7
s_add_u32 s44, s44, s45
s_waitcnt lgkmcnt(0)
s_barrier
s_mov_b32 s39, 0
s_mov_b32 s47, 0
L_loop1:
v_mfma_f32_16x16x32_bf16 v[12:15], a[36:39], a[0:3], v[12:15]
v_add_u32 v4, s47, v3
v_mfma_f32_16x16x32_bf16 v[12:15], a[40:43], a[4:7], v[12:15]
ds_read_b128 a[68:71], v4 offset:0
v_mfma_f32_16x16x32_bf16 v[16:19], a[40:43], a[8:11], v[16:19]
ds_read_b128 a[72:75], v4 offset:4096
v_mfma_f32_16x16x32_bf16 v[16:19], a[36:39], a[4:7], v[16:19]
ds_read_b128 a[76:79], v4 offset:8192
v_mfma_f32_16x16x32_bf16 v[16:19], a[32:35], a[0:3], v[16:19]
ds_read_b128 a[80:83], v4 offset:12288
v_mfma_f32_16x16x32_bf16 v[20:23], a[32:35], a[4:7], v[20:23]
ds_read_b128 a[84:87], v4 offset:16384
v_mfma_f32_16x16x32_bf16 v[20:23], a[36:39], a[8:11], v[20:23]
ds_read_b128 a[88:91], v4 offset:20480
v_mfma_f32_16x16x32_bf16 v[20:23], a[40:43], a[12:15], v[20:23]
ds_read_b128 a[92:95], v4 offset:24576
v_mfma_f32_16x16x32_bf16 v[24:27], a[40:43], a[16:19], v[24:27]
ds_read_b128 a[96:99], v4 offset:28672
v_mfma_f32_16x16x32_bf16 v[24:27], a[36:39], a[12:15], v[24:27]
ds_read_b64_tr_b16 v[92:93], v5 offset:64
v_mfma_f32_16x16x32_bf16 v[24:27], a[32:35], a[8:11], v[24:27]
ds_read_b64_tr_b16 v[94:95], v5 offset:1344
v_mfma_f32_16x16x32_bf16 v[28:31], a[32:35], a[12:15], v[28:31]
ds_read_b64_tr_b16 v[96:97], v5 offset:5184
v_mfma_f32_16x16x32_bf16 v[28:31], a[36:39], a[16:19], v[28:31]
ds_read_b64_tr_b16 v[98:99], v5 offset:6464
v_mfma_f32_16x16x32_bf16 v[28:31], a[40:43], a[20:23], v[28:31]
ds_read_b64_tr_b16 v[100:101], v5 offset:10304
v_mfma_f32_16x16x32_bf16 v[32:35], a[40:43], a[24:27], v[32:35]
ds_read_b64_tr_b16 v[102:103], v5 offset:11584
v_mfma_f32_16x16x32_bf16 v[32:35], a[36:39], a[20:23], v[32:35]
ds_read_b64_tr_b16 v[104:105], v5 offset:96
v_mfma_f32_16x16x32_bf16 v[32:35], a[32:35], a[16:19], v[32:35]
ds_read_b64_tr_b16 v[106:107], v5 offset:1376
v_mfma_f32_16x16x32_bf16 v[36:39], a[32:35], a[20:23], v[36:39]
ds_read_b64_tr_b16 v[108:109], v5 offset:5216
v_mfma_f32_16x16x32_bf16 v[36:39], a[36:39], a[24:27], v[36:39]
ds_read_b64_tr_b16 v[110:111], v5 offset:6496
v_mfma_f32_16x16x32_bf16 v[36:39], a[40:43], a[28:31], v[36:39]
ds_read_b64_tr_b16 v[112:113], v5 offset:10336
v_mfma_f32_16x16x32_bf16 v[40:43], a[36:39], a[28:31], v[40:43]
ds_read_b64_tr_b16 v[114:115], v5 offset:11616
v_mfma_f32_16x16x32_bf16 v[40:43], a[32:35], a[24:27], v[40:43]
ds_read_b64_tr_b16 v[116:117], v5 offset:128
v_mfma_f32_16x16x32_bf16 v[44:47], a[48:51], a[0:3], v[44:47]
ds_read_b64_tr_b16 v[118:119], v5 offset:1408
v_mfma_f32_16x16x32_bf16 v[44:47], a[52:55], a[4:7], v[44:47]
ds_read_b64_tr_b16 v[120:121], v5 offset:5248
v_mfma_f32_16x16x32_bf16 v[48:51], a[52:55], a[8:11], v[48:51]
ds_read_b64_tr_b16 v[122:123], v5 offset:6528
v_mfma_f32_16x16x32_bf16 v[48:51], a[48:51], a[4:7], v[48:51]
ds_read_b64_tr_b16 v[124:125], v5 offset:10368
v_mfma_f32_16x16x32_bf16 v[48:51], a[44:47], a[0:3], v[48:51]
ds_read_b64_tr_b16 v[126:127], v5 offset:11648
v_mfma_f32_16x16x32_bf16 v[52:55], a[44:47], a[4:7], v[52:55]
v_mfma_f32_16x16x32_bf16 v[52:55], a[48:51], a[8:11], v[52:55]
v_mfma_f32_16x16x32_bf16 v[52:55], a[52:55], a[12:15], v[52:55]
v_mfma_f32_16x16x32_bf16 v[56:59], a[52:55], a[16:19], v[56:59]
v_mfma_f32_16x16x32_bf16 v[56:59], a[48:51], a[12:15], v[56:59]
v_mfma_f32_16x16x32_bf16 v[56:59], a[44:47], a[8:11], v[56:59]
v_mfma_f32_16x16x32_bf16 v[60:63], a[44:47], a[12:15], v[60:63]
v_mfma_f32_16x16x32_bf16 v[60:63], a[48:51], a[16:19], v[60:63]
v_xor_b32 v5, 0x8000, v5
v_mfma_f32_16x16x32_bf16 v[60:63], a[52:55], a[20:23], v[60:63]
s_add_u32 s47, s47, 32768
v_mfma_f32_16x16x32_bf16 v[64:67], a[52:55], a[24:27], v[64:67]
s_cmp_eq_u32 s47, 98304
v_mfma_f32_16x16x32_bf16 v[64:67], a[48:51], a[20:23], v[64:67]
s_cselect_b32 s47, 0, s47
v_mfma_f32_16x16x32_bf16 v[64:67], a[44:47], a[16:19], v[64:67]
v_mfma_f32_16x16x32_bf16 v[68:71], a[44:47], a[20:23], v[68:71]
v_mfma_f32_16x16x32_bf16 v[68:71], a[48:51], a[24:27], v[68:71]
v_mfma_f32_16x16x32_bf16 v[68:71], a[52:55], a[28:31], v[68:71]
v_mfma_f32_16x16x32_bf16 v[72:75], a[48:51], a[28:31], v[72:75]
v_mfma_f32_16x16x32_bf16 v[72:75], a[44:47], a[24:27], v[72:75]
v_mfma_f32_16x16x32_bf16 v[76:79], a[56:59], a[12:15], v[76:79]
v_mfma_f32_16x16x32_bf16 v[76:79], a[60:63], a[16:19], v[76:79]
v_mfma_f32_16x16x32_bf16 v[76:79], a[64:67], a[20:23], v[76:79]
v_mfma_f32_16x16x32_bf16 v[80:83], a[64:67], a[24:27], v[80:83]
v_mfma_f32_16x16x32_bf16 v[80:83], a[60:63], a[20:23], v[80:83]
v_mfma_f32_16x16x32_bf16 v[80:83], a[56:59], a[16:19], v[80:83]
v_mfma_f32_16x16x32_bf16 v[84:87], a[56:59], a[20:23], v[84:87]
s_waitcnt lgkmcnt(0)
v_mfma_f32_16x16x32_bf16 v[84:87], a[60:63], a[24:27], v[84:87]
v_mfma_f32_16x16x32_bf16 v[84:87], a[64:67], a[28:31], v[84:87]
v_mfma_f32_16x16x32_bf16 v[88:91], a[60:63], a[28:31], v[88:91]
s_barrier
v_mfma_f32_16x16x32_bf16 v[88:91], a[56:59], a[24:27], v[88:91]
v_mfma_f32_16x16x32_bf16 v[12:15], v[96:99], a[68:71], v[12:15]
v_add_u32 v4, s47, v2
v_mfma_f32_16x16x32_bf16 v[12:15], v[100:103], a[72:75], v[12:15]
ds_read_b128 a[0:3], v4 offset:0
v_mfma_f32_16x16x32_bf16 v[16:19], v[100:103], a[76:79], v[16:19]
ds_read_b128 a[4:7], v4 offset:4096
v_mfma_f32_16x16x32_bf16 v[16:19], v[96:99], a[72:75], v[16:19]
ds_read_b128 a[8:11], v4 offset:8192
v_mfma_f32_16x16x32_bf16 v[16:19], v[92:95], a[68:71], v[16:19]
ds_read_b128 a[12:15], v4 offset:12288
v_mfma_f32_16x16x32_bf16 v[20:23], v[92:95], a[72:75], v[20:23]
ds_read_b128 a[16:19], v4 offset:16384
v_mfma_f32_16x16x32_bf16 v[20:23], v[96:99], a[76:79], v[20:23]
ds_read_b128 a[20:23], v4 offset:20480
v_mfma_f32_16x16x32_bf16 v[20:23], v[100:103], a[80:83], v[20:23]
ds_read_b128 a[24:27], v4 offset:24576
v_mfma_f32_16x16x32_bf16 v[24:27], v[100:103], a[84:87], v[24:27]
ds_read_b128 a[28:31], v4 offset:28672
v_mfma_f32_16x16x32_bf16 v[24:27], v[96:99], a[80:83], v[24:27]
ds_read_b64_tr_b16 a[32:33], v6 offset:64
v_mfma_f32_16x16x32_bf16 v[24:27], v[92:95], a[76:79], v[24:27]
ds_read_b64_tr_b16 a[34:35], v6 offset:1344
v_mfma_f32_16x16x32_bf16 v[28:31], v[92:95], a[80:83], v[28:31]
ds_read_b64_tr_b16 a[36:37], v6 offset:5184
v_mfma_f32_16x16x32_bf16 v[28:31], v[96:99], a[84:87], v[28:31]
ds_read_b64_tr_b16 a[38:39], v6 offset:6464
v_mfma_f32_16x16x32_bf16 v[28:31], v[100:103], a[88:91], v[28:31]
ds_read_b64_tr_b16 a[40:41], v6 offset:10304
v_mfma_f32_16x16x32_bf16 v[32:35], v[100:103], a[92:95], v[32:35]
ds_read_b64_tr_b16 a[42:43], v6 offset:11584
v_mfma_f32_16x16x32_bf16 v[32:35], v[96:99], a[88:91], v[32:35]
ds_read_b64_tr_b16 a[44:45], v6 offset:96
v_mfma_f32_16x16x32_bf16 v[32:35], v[92:95], a[84:87], v[32:35]
ds_read_b64_tr_b16 a[46:47], v6 offset:1376
v_mfma_f32_16x16x32_bf16 v[36:39], v[92:95], a[88:91], v[36:39]
ds_read_b64_tr_b16 a[48:49], v6 offset:5216
v_mfma_f32_16x16x32_bf16 v[36:39], v[96:99], a[92:95], v[36:39]
ds_read_b64_tr_b16 a[50:51], v6 offset:6496
v_mfma_f32_16x16x32_bf16 v[36:39], v[100:103], a[96:99], v[36:39]
ds_read_b64_tr_b16 a[52:53], v6 offset:10336
v_mfma_f32_16x16x32_bf16 v[40:43], v[96:99], a[96:99], v[40:43]
ds_read_b64_tr_b16 a[54:55], v6 offset:11616
v_mfma_f32_16x16x32_bf16 v[40:43], v[92:95], a[92:95], v[40:43]
ds_read_b64_tr_b16 a[56:57], v6 offset:128
v_mfma_f32_16x16x32_bf16 v[44:47], v[108:111], a[68:71], v[44:47]
ds_read_b64_tr_b16 a[58:59], v6 offset:1408
v_mfma_f32_16x16x32_bf16 v[44:47], v[112:115], a[72:75], v[44:47]
ds_read_b64_tr_b16 a[60:61], v6 offset:5248
v_mfma_f32_16x16x32_bf16 v[48:51], v[112:115], a[76:79], v[48:51]
ds_read_b64_tr_b16 a[62:63], v6 offset:6528
v_mfma_f32_16x16x32_bf16 v[48:51], v[108:111], a[72:75], v[48:51]
ds_read_b64_tr_b16 a[64:65], v6 offset:10368
v_mfma_f32_16x16x32_bf16 v[48:51], v[104:107], a[68:71], v[48:51]
ds_read_b64_tr_b16 a[66:67], v6 offset:11648
v_mfma_f32_16x16x32_bf16 v[52:55], v[104:107], a[72:75], v[52:55]
v_mfma_f32_16x16x32_bf16 v[52:55], v[108:111], a[76:79], v[52:55]
v_mfma_f32_16x16x32_bf16 v[52:55], v[112:115], a[80:83], v[52:55]
v_mfma_f32_16x16x32_bf16 v[56:59], v[112:115], a[84:87], v[56:59]
v_mfma_f32_16x16x32_bf16 v[56:59], v[108:111], a[80:83], v[56:59]
v_mfma_f32_16x16x32_bf16 v[56:59], v[104:107], a[76:79], v[56:59]
v_mfma_f32_16x16x32_bf16 v[60:63], v[104:107], a[80:83], v[60:63]
v_mfma_f32_16x16x32_bf16 v[60:63], v[108:111], a[84:87], v[60:63]
v_xor_b32 v6, 0x8000, v6
v_mfma_f32_16x16x32_bf16 v[60:63], v[112:115], a[88:91], v[60:63]
s_add_u32 s39, s39, 1
v_mfma_f32_16x16x32_bf16 v[64:67], v[112:115], a[92:95], v[64:67]
s_cmp_lt_u32 s39, 9
v_mfma_f32_16x16x32_bf16 v[64:67], v[108:111], a[88:91], v[64:67]
v_mfma_f32_16x16x32_bf16 v[64:67], v[104:107], a[84:87], v[64:67]
v_mfma_f32_16x16x32_bf16 v[68:71], v[104:107], a[88:91], v[68:71]
v_mfma_f32_16x16x32_bf16 v[68:71], v[108:111], a[92:95], v[68:71]
v_mfma_f32_16x16x32_bf16 v[68:71], v[112:115], a[96:99], v[68:71]
v_mfma_f32_16x16x32_bf16 v[72:75], v[108:111], a[96:99], v[72:75]
v_mfma_f32_16x16x32_bf16 v[72:75], v[104:107], a[92:95], v[72:75]
v_mfma_f32_16x16x32_bf16 v[76:79], v[116:119], a[80:83], v[76:79]
v_mfma_f32_16x16x32_bf16 v[76:79], v[120:123], a[84:87], v[76:79]
v_mfma_f32_16x16x32_bf16 v[76:79], v[124:127], a[88:91], v[76:79]
v_mfma_f32_16x16x32_bf16 v[80:83], v[124:127], a[92:95], v[80:83]
v_mfma_f32_16x16x32_bf16 v[80:83], v[120:123], a[88:91], v[80:83]
v_mfma_f32_16x16x32_bf16 v[80:83], v[116:119], a[84:87], v[80:83]
v_mfma_f32_16x16x32_bf16 v[84:87], v[116:119], a[88:91], v[84:87]
s_waitcnt lgkmcnt(0)
v_mfma_f32_16x16x32_bf16 v[84:87], v[120:123], a[92:95], v[84:87]
v_mfma_f32_16x16x32_bf16 v[84:87], v[124:127], a[96:99], v[84:87]
v_mfma_f32_16x16x32_bf16 v[88:91], v[120:123], a[96:99], v[88:91]
s_barrier
v_mfma_f32_16x16x32_bf16 v[88:91], v[116:119], a[92:95], v[88:91]
s_cbranch_scc1 L_loop1
v_add_u32 v4, s47, v3
v_mfma_f32_16x16x32_bf16 v[12:15], a[36:39], a[0:3], v[12:15]
ds_read_b128 a[68:71], v4 offset:0
ds_read_b64_tr_b16 v[96:97], v5 offset:5184
v_mfma_f32_16x16x32_bf16 v[12:15], a[40:43], a[4:7], v[12:15]
ds_read_b64_tr_b16 v[98:99], v5 offset:6464
ds_read_b64_tr_b16 v[108:109], v5 offset:5216
v_mfma_f32_16x16x32_bf16 v[44:47], a[48:51], a[0:3], v[44:47]
ds_read_b64_tr_b16 v[110:111], v5 offset:6496
ds_read_b128 a[72:75], v4 offset:4096
v_mfma_f32_16x16x32_bf16 v[44:47], a[52:55], a[4:7], v[44:47]
ds_read_b64_tr_b16 v[100:101], v5 offset:10304
ds_read_b64_tr_b16 v[102:103], v5 offset:11584
v_mfma_f32_16x16x32_bf16 v[16:19], a[40:43], a[8:11], v[16:19]
ds_read_b64_tr_b16 v[112:113], v5 offset:10336
ds_read_b64_tr_b16 v[114:115], v5 offset:11616
v_mfma_f32_16x16x32_bf16 v[16:19], a[36:39], a[4:7], v[16:19]
ds_read_b128 v[130:133], v9 offset:128
ds_read_b128 v[138:141], v9 offset:448
v_mfma_f32_16x16x32_bf16 v[16:19], a[32:35], a[0:3], v[16:19]
ds_read_b128 v[134:137], v9 offset:192
ds_read_b128 v[142:145], v9 offset:512
v_mfma_f32_16x16x32_bf16 v[48:51], a[52:55], a[8:11], v[48:51]
ds_read_b64_tr_b16 v[92:93], v5 offset:64
v_mfma_f32_16x16x32_bf16 v[48:51], a[48:51], a[4:7], v[48:51]
v_mfma_f32_16x16x32_bf16 v[48:51], a[44:47], a[0:3], v[48:51]
v_mfma_f32_16x16x32_bf16 v[20:23], a[32:35], a[4:7], v[20:23]
v_mfma_f32_16x16x32_bf16 v[20:23], a[36:39], a[8:11], v[20:23]
s_waitcnt lgkmcnt(1)
v_mfma_f32_16x16x32_bf16 v[12:15], v[96:99], a[68:71], v[12:15]
ds_read_b64_tr_b16 v[94:95], v5 offset:1344
ds_read_b128 a[76:79], v4 offset:8192
v_mfma_f32_16x16x32_bf16 v[12:15], v[100:103], a[72:75], v[12:15]
ds_read_b64_tr_b16 v[104:105], v5 offset:96
ds_read_b64_tr_b16 v[106:107], v5 offset:1376
v_mfma_f32_16x16x32_bf16 v[44:47], v[108:111], a[68:71], v[44:47]
ds_read_b128 a[80:83], v4 offset:12288
ds_read_b128 a[84:87], v4 offset:16384
v_mfma_f32_16x16x32_bf16 v[44:47], v[112:115], a[72:75], v[44:47]
ds_read_b128 a[88:91], v4 offset:20480
ds_read_b128 a[92:95], v4 offset:24576
v_mfma_f32_16x16x32_bf16 v[20:23], a[40:43], a[12:15], v[20:23]
ds_read_b128 a[96:99], v4 offset:28672
ds_read_b64_tr_b16 v[116:117], v5 offset:128
v_mfma_f32_16x16x32_bf16 v[52:55], a[44:47], a[4:7], v[52:55]
ds_read_b64_tr_b16 v[118:119], v5 offset:1408
ds_read_b64_tr_b16 v[120:121], v5 offset:5248
v_mfma_f32_16x16x32_bf16 v[52:55], a[48:51], a[8:11], v[52:55]
ds_read_b64_tr_b16 v[122:123], v5 offset:6528
ds_read_b64_tr_b16 v[124:125], v5 offset:10368
v_mfma_f32_16x16x32_bf16 v[52:55], a[52:55], a[12:15], v[52:55]
ds_read_b64_tr_b16 v[126:127], v5 offset:11648
v_mfma_f32_16x16x32_bf16 v[24:27], a[40:43], a[16:19], v[24:27]
v_mfma_f32_16x16x32_bf16 v[24:27], a[36:39], a[12:15], v[24:27]
v_pk_fma_f32 v[12:13], v[12:13], v[130:131], v[138:139]
v_pk_fma_f32 v[14:15], v[14:15], v[132:133], v[140:141]
v_pk_fma_f32 v[44:45], v[44:45], v[134:135], v[142:143]
v_pk_fma_f32 v[46:47], v[46:47], v[136:137], v[144:145]
v_mfma_f32_16x16x32_bf16 v[24:27], a[32:35], a[8:11], v[24:27]
v_exp_f32 v146, v12
v_mfma_f32_16x16x32_bf16 v[56:59], a[52:55], a[16:19], v[56:59]
v_exp_f32 v147, v13
v_mfma_f32_16x16x32_bf16 v[56:59], a[48:51], a[12:15], v[56:59]
v_exp_f32 v148, v14
v_mfma_f32_16x16x32_bf16 v[56:59], a[44:47], a[8:11], v[56:59]
v_exp_f32 v149, v15
s_waitcnt lgkmcnt(0)
v_mfma_f32_16x16x32_bf16 v[16:19], v[100:103], a[76:79], v[16:19]
v_exp_f32 v150, v44
v_exp_f32 v151, v45
v_exp_f32 v152, v46
v_exp_f32 v153, v47
v_pk_fma_f32 v[146:147], v[146:147], s[52:53], s[52:53]
v_pk_fma_f32 v[148:149], v[148:149], s[52:53], s[52:53]
v_pk_fma_f32 v[150:151], v[150:151], s[52:53], s[52:53]
v_pk_fma_f32 v[152:153], v[152:153], s[52:53], s[52:53]
v_mfma_f32_16x16x32_bf16 v[16:19], v[96:99], a[72:75], v[16:19]
v_rcp_f32 v146, v146
v_mfma_f32_16x16x32_bf16 v[16:19], v[92:95], a[68:71], v[16:19]
v_rcp_f32 v147, v147
v_mfma_f32_16x16x32_bf16 v[48:51], v[112:115], a[76:79], v[48:51]
v_rcp_f32 v148, v148
v_mfma_f32_16x16x32_bf16 v[48:51], v[108:111], a[72:75], v[48:51]
v_rcp_f32 v149, v149
v_mfma_f32_16x16x32_bf16 v[48:51], v[104:107], a[68:71], v[48:51]
v_rcp_f32 v150, v150
v_rcp_f32 v151, v151
v_rcp_f32 v152, v152
v_rcp_f32 v153, v153
s_add_u32 s45, s44, 0
v_pk_mul_f32 v[12:13], v[12:13], v[146:147] neg_lo:[1,0] neg_hi:[1,0]
v_pk_mul_f32 v[14:15], v[14:15], v[148:149] neg_lo:[1,0] neg_hi:[1,0]
v_pk_mul_f32 v[44:45], v[44:45], v[150:151] neg_lo:[1,0] neg_hi:[1,0]
v_pk_mul_f32 v[46:47], v[46:47], v[152:153] neg_lo:[1,0] neg_hi:[1,0]
v_cvt_pk_bf16_f32 v12, v12, v13
v_cvt_pk_bf16_f32 v13, v14, v15
v_cvt_pk_bf16_f32 v14, v44, v45
v_cvt_pk_bf16_f32 v15, v46, v47
v_pk_fma_f32 v[16:17], v[16:17], v[130:131], v[138:139]
v_pk_fma_f32 v[18:19], v[18:19], v[132:133], v[140:141]
v_pk_fma_f32 v[48:49], v[48:49], v[134:135], v[142:143]
v_pk_fma_f32 v[50:51], v[50:51], v[136:137], v[144:145]
v_permlane16_swap_b32 v12, v14
v_permlane16_swap_b32 v13, v15
v_mfma_f32_16x16x32_bf16 v[20:23], v[92:95], a[72:75], v[20:23]
v_exp_f32 v146, v16
v_mfma_f32_16x16x32_bf16 v[20:23], v[96:99], a[76:79], v[20:23]
v_exp_f32 v147, v17
v_mfma_f32_16x16x32_bf16 v[20:23], v[100:103], a[80:83], v[20:23]
v_exp_f32 v148, v18
v_mfma_f32_16x16x32_bf16 v[52:55], v[104:107], a[72:75], v[52:55]
v_exp_f32 v149, v19
v_mfma_f32_16x16x32_bf16 v[52:55], v[108:111], a[76:79], v[52:55]
v_exp_f32 v150, v48
v_exp_f32 v151, v49
buffer_store_dwordx4 v[12:15], v7, s[28:31], s45 offen sc1
v_exp_f32 v152, v50
v_exp_f32 v153, v51
v_pk_fma_f32 v[146:147], v[146:147], s[52:53], s[52:53]
v_pk_fma_f32 v[148:149], v[148:149], s[52:53], s[52:53]
v_pk_fma_f32 v[150:151], v[150:151], s[52:53], s[52:53]
v_pk_fma_f32 v[152:153], v[152:153], s[52:53], s[52:53]
v_mfma_f32_16x16x32_bf16 v[52:55], v[112:115], a[80:83], v[52:55]
v_rcp_f32 v146, v146
v_mfma_f32_16x16x32_bf16 v[28:31], a[32:35], a[12:15], v[28:31]
v_rcp_f32 v147, v147
v_mfma_f32_16x16x32_bf16 v[28:31], a[36:39], a[16:19], v[28:31]
v_rcp_f32 v148, v148
v_mfma_f32_16x16x32_bf16 v[28:31], a[40:43], a[20:23], v[28:31]
v_rcp_f32 v149, v149
v_mfma_f32_16x16x32_bf16 v[60:63], a[44:47], a[12:15], v[60:63]
v_rcp_f32 v150, v150
v_rcp_f32 v151, v151
v_rcp_f32 v152, v152
v_rcp_f32 v153, v153
s_add_u32 s46, s44, 1280
v_pk_mul_f32 v[16:17], v[16:17], v[146:147] neg_lo:[1,0] neg_hi:[1,0]
v_pk_mul_f32 v[18:19], v[18:19], v[148:149] neg_lo:[1,0] neg_hi:[1,0]
v_pk_mul_f32 v[48:49], v[48:49], v[150:151] neg_lo:[1,0] neg_hi:[1,0]
v_pk_mul_f32 v[50:51], v[50:51], v[152:153] neg_lo:[1,0] neg_hi:[1,0]
v_cvt_pk_bf16_f32 v16, v16, v17
v_cvt_pk_bf16_f32 v17, v18, v19
v_cvt_pk_bf16_f32 v18, v48, v49
v_cvt_pk_bf16_f32 v19, v50, v51
v_pk_fma_f32 v[20:21], v[20:21], v[130:131], v[138:139]
v_pk_fma_f32 v[22:23], v[22:23], v[132:133], v[140:141]
v_pk_fma_f32 v[52:53], v[52:53], v[134:135], v[142:143]
v_pk_fma_f32 v[54:55], v[54:55], v[136:137], v[144:145]
v_permlane16_swap_b32 v16, v18
v_permlane16_swap_b32 v17, v19
v_mfma_f32_16x16x32_bf16 v[24:27], v[100:103], a[84:87], v[24:27]
v_exp_f32 v146, v20
v_mfma_f32_16x16x32_bf16 v[24:27], v[96:99], a[80:83], v[24:27]
v_exp_f32 v147, v21
v_mfma_f32_16x16x32_bf16 v[24:27], v[92:95], a[76:79], v[24:27]
v_exp_f32 v148, v22
v_mfma_f32_16x16x32_bf16 v[56:59], v[112:115], a[84:87], v[56:59]
v_exp_f32 v149, v23
v_mfma_f32_16x16x32_bf16 v[56:59], v[108:111], a[80:83], v[56:59]
v_exp_f32 v150, v52
v_exp_f32 v151, v53
buffer_store_dwordx4 v[16:19], v7, s[28:31], s46 offen sc1
v_exp_f32 v152, v54
v_exp_f32 v153, v55
v_pk_fma_f32 v[146:147], v[146:147], s[52:53], s[52:53]
v_pk_fma_f32 v[148:149], v[148:149], s[52:53], s[52:53]
v_pk_fma_f32 v[150:151], v[150:151], s[52:53], s[52:53]
v_pk_fma_f32 v[152:153], v[152:153], s[52:53], s[52:53]
v_mfma_f32_16x16x32_bf16 v[56:59], v[104:107], a[76:79], v[56:59]
v_rcp_f32 v146, v146
v_mfma_f32_16x16x32_bf16 v[60:63], a[48:51], a[16:19], v[60:63]
v_rcp_f32 v147, v147
v_mfma_f32_16x16x32_bf16 v[60:63], a[52:55], a[20:23], v[60:63]
v_rcp_f32 v148, v148
v_mfma_f32_16x16x32_bf16 v[32:35], a[40:43], a[24:27], v[32:35]
v_rcp_f32 v149, v149
v_mfma_f32_16x16x32_bf16 v[32:35], a[36:39], a[20:23], v[32:35]
v_rcp_f32 v150, v150
v_rcp_f32 v151, v151
v_rcp_f32 v152, v152
v_rcp_f32 v153, v153
ds_read_b128 v[44:47], v9 offset:256
ds_read_b128 v[48:51], v9 offset:576
s_add_u32 s45, s44, 2560
v_pk_mul_f32 v[20:21], v[20:21], v[146:147] neg_lo:[1,0] neg_hi:[1,0]
v_pk_mul_f32 v[22:23], v[22:23], v[148:149] neg_lo:[1,0] neg_hi:[1,0]
v_pk_mul_f32 v[52:53], v[52:53], v[150:151] neg_lo:[1,0] neg_hi:[1,0]
v_pk_mul_f32 v[54:55], v[54:55], v[152:153] neg_lo:[1,0] neg_hi:[1,0]
v_cvt_pk_bf16_f32 v20, v20, v21
v_cvt_pk_bf16_f32 v21, v22, v23
v_cvt_pk_bf16_f32 v22, v52, v53
v_cvt_pk_bf16_f32 v23, v54, v55
v_pk_fma_f32 v[24:25], v[24:25], v[130:131], v[138:139]
v_pk_fma_f32 v[26:27], v[26:27], v[132:133], v[140:141]
v_pk_fma_f32 v[56:57], v[56:57], v[134:135], v[142:143]
v_pk_fma_f32 v[58:59], v[58:59], v[136:137], v[144:145]
v_permlane16_swap_b32 v20, v22
v_permlane16_swap_b32 v21, v23
v_mfma_f32_16x16x32_bf16 v[28:31], v[92:95], a[80:83], v[28:31]
v_exp_f32 v146, v24
v_mfma_f32_16x16x32_bf16 v[28:31], v[96:99], a[84:87], v[28:31]
v_exp_f32 v147, v25
v_mfma_f32_16x16x32_bf16 v[28:31], v[100:103], a[88:91], v[28:31]
v_exp_f32 v148, v26
v_mfma_f32_16x16x32_bf16 v[60:63], v[104:107], a[80:83], v[60:63]
v_exp_f32 v149, v27
v_mfma_f32_16x16x32_bf16 v[60:63], v[108:111], a[84:87], v[60:63]
v_exp_f32 v150, v56
v_exp_f32 v151, v57
buffer_store_dwordx4 v[20:23], v7, s[28:31], s45 offen sc1
v_exp_f32 v152, v58
v_exp_f32 v153, v59
v_pk_fma_f32 v[146:147], v[146:147], s[52:53], s[52:53]
v_pk_fma_f32 v[148:149], v[148:149], s[52:53], s[52:53]
v_pk_fma_f32 v[150:151], v[150:151], s[52:53], s[52:53]
v_pk_fma_f32 v[152:153], v[152:153], s[52:53], s[52:53]
v_mfma_f32_16x16x32_bf16 v[60:63], v[112:115], a[88:91], v[60:63]
v_rcp_f32 v146, v146
v_mfma_f32_16x16x32_bf16 v[32:35], a[32:35], a[16:19], v[32:35]
v_rcp_f32 v147, v147
v_mfma_f32_16x16x32_bf16 v[64:67], a[52:55], a[24:27], v[64:67]
v_rcp_f32 v148, v148
v_mfma_f32_16x16x32_bf16 v[64:67], a[48:51], a[20:23], v[64:67]
v_rcp_f32 v149, v149
v_mfma_f32_16x16x32_bf16 v[64:67], a[44:47], a[16:19], v[64:67]
v_rcp_f32 v150, v150
v_rcp_f32 v151, v151
v_rcp_f32 v152, v152
v_rcp_f32 v153, v153
s_add_u32 s46, s44, 3840
v_pk_mul_f32 v[24:25], v[24:25], v[146:147] neg_lo:[1,0] neg_hi:[1,0]
v_pk_mul_f32 v[26:27], v[26:27], v[148:149] neg_lo:[1,0] neg_hi:[1,0]
v_pk_mul_f32 v[56:57], v[56:57], v[150:151] neg_lo:[1,0] neg_hi:[1,0]
v_pk_mul_f32 v[58:59], v[58:59], v[152:153] neg_lo:[1,0] neg_hi:[1,0]
v_cvt_pk_bf16_f32 v24, v24, v25
v_cvt_pk_bf16_f32 v25, v26, v27
v_cvt_pk_bf16_f32 v26, v56, v57
v_cvt_pk_bf16_f32 v27, v58, v59
v_pk_fma_f32 v[28:29], v[28:29], v[130:131], v[138:139]
v_pk_fma_f32 v[30:31], v[30:31], v[132:133], v[140:141]
v_pk_fma_f32 v[60:61], v[60:61], v[134:135], v[142:143]
v_pk_fma_f32 v[62:63], v[62:63], v[136:137], v[144:145]
v_permlane16_swap_b32 v24, v26
v_permlane16_swap_b32 v25, v27
v_mfma_f32_16x16x32_bf16 v[32:35], v[100:103], a[92:95], v[32:35]
v_exp_f32 v146, v28
v_mfma_f32_16x16x32_bf16 v[32:35], v[96:99], a[88:91], v[32:35]
v_exp_f32 v147, v29
v_mfma_f32_16x16x32_bf16 v[32:35], v[92:95], a[84:87], v[32:35]
v_exp_f32 v148, v30
v_mfma_f32_16x16x32_bf16 v[64:67], v[112:115], a[92:95], v[64:67]
v_exp_f32 v149, v31
v_mfma_f32_16x16x32_bf16 v[64:67], v[108:111], a[88:91], v[64:67]
v_exp_f32 v150, v60
v_exp_f32 v151, v61
buffer_store_dwordx4 v[24:27], v7, s[28:31], s46 offen sc1
v_exp_f32 v152, v62
v_exp_f32 v153, v63
v_pk_fma_f32 v[146:147], v[146:147], s[52:53], s[52:53]
v_pk_fma_f32 v[148:149], v[148:149], s[52:53], s[52:53]
v_pk_fma_f32 v[150:151], v[150:151], s[52:53], s[52:53]
v_pk_fma_f32 v[152:153], v[152:153], s[52:53], s[52:53]
v_mfma_f32_16x16x32_bf16 v[64:67], v[104:107], a[84:87], v[64:67]
v_rcp_f32 v146, v146
v_mfma_f32_16x16x32_bf16 v[36:39], a[32:35], a[20:23], v[36:39]
v_rcp_f32 v147, v147
v_mfma_f32_16x16x32_bf16 v[36:39], a[36:39], a[24:27], v[36:39]
v_rcp_f32 v148, v148
v_mfma_f32_16x16x32_bf16 v[36:39], a[40:43], a[28:31], v[36:39]
v_rcp_f32 v149, v149
v_mfma_f32_16x16x32_bf16 v[68:71], a[44:47], a[20:23], v[68:71]
v_rcp_f32 v150, v150
v_rcp_f32 v151, v151
v_rcp_f32 v152, v152
v_rcp_f32 v153, v153
s_add_u32 s45, s44, 5120
v_pk_mul_f32 v[28:29], v[28:29], v[146:147] neg_lo:[1,0] neg_hi:[1,0]
v_pk_mul_f32 v[30:31], v[30:31], v[148:149] neg_lo:[1,0] neg_hi:[1,0]
v_pk_mul_f32 v[60:61], v[60:61], v[150:151] neg_lo:[1,0] neg_hi:[1,0]
v_pk_mul_f32 v[62:63], v[62:63], v[152:153] neg_lo:[1,0] neg_hi:[1,0]
v_cvt_pk_bf16_f32 v28, v28, v29
v_cvt_pk_bf16_f32 v29, v30, v31
v_cvt_pk_bf16_f32 v30, v60, v61
v_cvt_pk_bf16_f32 v31, v62, v63
v_pk_fma_f32 v[32:33], v[32:33], v[130:131], v[138:139]
v_pk_fma_f32 v[34:35], v[34:35], v[132:133], v[140:141]
v_pk_fma_f32 v[64:65], v[64:65], v[134:135], v[142:143]
v_pk_fma_f32 v[66:67], v[66:67], v[136:137], v[144:145]
v_permlane16_swap_b32 v28, v30
v_permlane16_swap_b32 v29, v31
v_mfma_f32_16x16x32_bf16 v[68:71], a[48:51], a[24:27], v[68:71]
v_exp_f32 v146, v32
v_mfma_f32_16x16x32_bf16 v[68:71], a[52:55], a[28:31], v[68:71]
v_exp_f32 v147, v33
v_mfma_f32_16x16x32_bf16 v[36:39], v[92:95], a[88:91], v[36:39]
v_exp_f32 v148, v34
v_mfma_f32_16x16x32_bf16 v[36:39], v[96:99], a[92:95], v[36:39]
v_exp_f32 v149, v35
v_mfma_f32_16x16x32_bf16 v[36:39], v[100:103], a[96:99], v[36:39]
v_exp_f32 v150, v64
v_exp_f32 v151, v65
buffer_store_dwordx4 v[28:31], v7, s[28:31], s45 offen sc1
v_exp_f32 v152, v66
v_exp_f32 v153, v67
v_pk_fma_f32 v[146:147], v[146:147], s[52:53], s[52:53]
v_pk_fma_f32 v[148:149], v[148:149], s[52:53], s[52:53]
v_pk_fma_f32 v[150:151], v[150:151], s[52:53], s[52:53]
v_pk_fma_f32 v[152:153], v[152:153], s[52:53], s[52:53]
v_mfma_f32_16x16x32_bf16 v[68:71], v[104:107], a[88:91], v[68:71]
v_rcp_f32 v146, v146
v_mfma_f32_16x16x32_bf16 v[68:71], v[108:111], a[92:95], v[68:71]
v_rcp_f32 v147, v147
v_mfma_f32_16x16x32_bf16 v[68:71], v[112:115], a[96:99], v[68:71]
v_rcp_f32 v148, v148
v_mfma_f32_16x16x32_bf16 v[40:43], a[36:39], a[28:31], v[40:43]
v_rcp_f32 v149, v149
v_mfma_f32_16x16x32_bf16 v[40:43], a[32:35], a[24:27], v[40:43]
v_rcp_f32 v150, v150
v_rcp_f32 v151, v151
v_rcp_f32 v152, v152
v_rcp_f32 v153, v153
s_add_u32 s46, s44, 6400
v_pk_mul_f32 v[32:33], v[32:33], v[146:147] neg_lo:[1,0] neg_hi:[1,0]
v_pk_mul_f32 v[34:35], v[34:35], v[148:149] neg_lo:[1,0] neg_hi:[1,0]
v_pk_mul_f32 v[64:65], v[64:65], v[150:151] neg_lo:[1,0] neg_hi:[1,0]
v_pk_mul_f32 v[66:67], v[66:67], v[152:153] neg_lo:[1,0] neg_hi:[1,0]
v_cvt_pk_bf16_f32 v32, v32, v33
v_cvt_pk_bf16_f32 v33, v34, v35
v_cvt_pk_bf16_f32 v34, v64, v65
v_cvt_pk_bf16_f32 v35, v66, v67
v_pk_fma_f32 v[36:37], v[36:37], v[130:131], v[138:139]
v_pk_fma_f32 v[38:39], v[38:39], v[132:133], v[140:141]
v_pk_fma_f32 v[68:69], v[68:69], v[134:135], v[142:143]
v_pk_fma_f32 v[70:71], v[70:71], v[136:137], v[144:145]
v_permlane16_swap_b32 v32, v34
v_permlane16_swap_b32 v33, v35
v_mfma_f32_16x16x32_bf16 v[72:75], a[48:51], a[28:31], v[72:75]
v_exp_f32 v146, v36
v_mfma_f32_16x16x32_bf16 v[72:75], a[44:47], a[24:27], v[72:75]
v_exp_f32 v147, v37
v_mfma_f32_16x16x32_bf16 v[40:43], v[96:99], a[96:99], v[40:43]
v_exp_f32 v148, v38
v_mfma_f32_16x16x32_bf16 v[40:43], v[92:95], a[92:95], v[40:43]
v_exp_f32 v149, v39
v_mfma_f32_16x16x32_bf16 v[72:75], v[108:111], a[96:99], v[72:75]
v_exp_f32 v150, v68
v_mfma_f32_16x16x32_bf16 v[72:75], v[104:107], a[92:95], v[72:75]
v_exp_f32 v151, v69
buffer_store_dwordx4 v[32:35], v7, s[28:31], s46 offen sc1
v_exp_f32 v152, v70
v_exp_f32 v153, v71
v_pk_fma_f32 v[146:147], v[146:147], s[52:53], s[52:53]
v_pk_fma_f32 v[148:149], v[148:149], s[52:53], s[52:53]
v_pk_fma_f32 v[150:151], v[150:151], s[52:53], s[52:53]
v_pk_fma_f32 v[152:153], v[152:153], s[52:53], s[52:53]
v_mfma_f32_16x16x32_bf16 v[76:79], a[56:59], a[12:15], v[76:79]
v_rcp_f32 v146, v146
v_mfma_f32_16x16x32_bf16 v[76:79], a[60:63], a[16:19], v[76:79]
v_rcp_f32 v147, v147
v_mfma_f32_16x16x32_bf16 v[76:79], a[64:67], a[20:23], v[76:79]
v_rcp_f32 v148, v148
v_mfma_f32_16x16x32_bf16 v[80:83], a[64:67], a[24:27], v[80:83]
v_rcp_f32 v149, v149
v_mfma_f32_16x16x32_bf16 v[80:83], a[60:63], a[20:23], v[80:83]
v_rcp_f32 v150, v150
v_mfma_f32_16x16x32_bf16 v[80:83], a[56:59], a[16:19], v[80:83]
v_rcp_f32 v151, v151
v_rcp_f32 v152, v152
v_rcp_f32 v153, v153
s_add_u32 s45, s44, 7680
v_pk_mul_f32 v[36:37], v[36:37], v[146:147] neg_lo:[1,0] neg_hi:[1,0]
v_pk_mul_f32 v[38:39], v[38:39], v[148:149] neg_lo:[1,0] neg_hi:[1,0]
v_pk_mul_f32 v[68:69], v[68:69], v[150:151] neg_lo:[1,0] neg_hi:[1,0]
v_pk_mul_f32 v[70:71], v[70:71], v[152:153] neg_lo:[1,0] neg_hi:[1,0]
v_cvt_pk_bf16_f32 v36, v36, v37
v_cvt_pk_bf16_f32 v37, v38, v39
v_cvt_pk_bf16_f32 v38, v68, v69
v_cvt_pk_bf16_f32 v39, v70, v71
v_pk_fma_f32 v[40:41], v[40:41], v[130:131], v[138:139]
v_pk_fma_f32 v[42:43], v[42:43], v[132:133], v[140:141]
v_pk_fma_f32 v[72:73], v[72:73], v[134:135], v[142:143]
v_pk_fma_f32 v[74:75], v[74:75], v[136:137], v[144:145]
v_permlane16_swap_b32 v36, v38
v_permlane16_swap_b32 v37, v39
v_mfma_f32_16x16x32_bf16 v[76:79], v[116:119], a[80:83], v[76:79]
v_exp_f32 v146, v40
v_mfma_f32_16x16x32_bf16 v[76:79], v[120:123], a[84:87], v[76:79]
v_exp_f32 v147, v41
v_mfma_f32_16x16x32_bf16 v[76:79], v[124:127], a[88:91], v[76:79]
v_exp_f32 v148, v42
v_mfma_f32_16x16x32_bf16 v[80:83], v[124:127], a[92:95], v[80:83]
v_exp_f32 v149, v43
v_mfma_f32_16x16x32_bf16 v[80:83], v[120:123], a[88:91], v[80:83]
v_exp_f32 v150, v72
v_exp_f32 v151, v73
buffer_store_dwordx4 v[36:39], v7, s[28:31], s45 offen sc1
v_exp_f32 v152, v74
v_exp_f32 v153, v75
v_pk_fma_f32 v[146:147], v[146:147], s[52:53], s[52:53]
v_pk_fma_f32 v[148:149], v[148:149], s[52:53], s[52:53]
v_pk_fma_f32 v[150:151], v[150:151], s[52:53], s[52:53]
v_pk_fma_f32 v[152:153], v[152:153], s[52:53], s[52:53]
v_mfma_f32_16x16x32_bf16 v[80:83], v[116:119], a[84:87], v[80:83]
v_rcp_f32 v146, v146
v_mfma_f32_16x16x32_bf16 v[84:87], a[56:59], a[20:23], v[84:87]
v_rcp_f32 v147, v147
v_mfma_f32_16x16x32_bf16 v[84:87], a[60:63], a[24:27], v[84:87]
v_rcp_f32 v148, v148
v_rcp_f32 v149, v149
v_mfma_f32_16x16x32_bf16 v[84:87], a[64:67], a[28:31], v[84:87]
v_rcp_f32 v150, v150
v_rcp_f32 v151, v151
v_rcp_f32 v152, v152
v_rcp_f32 v153, v153
s_add_u32 s46, s44, 8960
v_pk_mul_f32 v[40:41], v[40:41], v[146:147] neg_lo:[1,0] neg_hi:[1,0]
v_pk_mul_f32 v[42:43], v[42:43], v[148:149] neg_lo:[1,0] neg_hi:[1,0]
v_pk_mul_f32 v[72:73], v[72:73], v[150:151] neg_lo:[1,0] neg_hi:[1,0]
v_pk_mul_f32 v[74:75], v[74:75], v[152:153] neg_lo:[1,0] neg_hi:[1,0]
v_cvt_pk_bf16_f32 v40, v40, v41
v_cvt_pk_bf16_f32 v41, v42, v43
v_cvt_pk_bf16_f32 v42, v72, v73
v_cvt_pk_bf16_f32 v43, v74, v75
s_waitcnt lgkmcnt(0)
v_pk_fma_f32 v[76:77], v[76:77], v[44:45], v[48:49]
v_pk_fma_f32 v[78:79], v[78:79], v[46:47], v[50:51]
v_pk_fma_f32 v[80:81], v[80:81], v[44:45], v[48:49]
v_pk_fma_f32 v[82:83], v[82:83], v[46:47], v[50:51]
v_permlane16_swap_b32 v40, v42
v_permlane16_swap_b32 v41, v43
buffer_store_dwordx4 v[40:43], v7, s[28:31], s46 offen sc1
v_mfma_f32_16x16x32_bf16 v[84:87], v[116:119], a[88:91], v[84:87]
v_exp_f32 v146, v76
v_mfma_f32_16x16x32_bf16 v[84:87], v[120:123], a[92:95], v[84:87]
v_exp_f32 v147, v77
v_mfma_f32_16x16x32_bf16 v[84:87], v[124:127], a[96:99], v[84:87]
v_exp_f32 v148, v78
v_exp_f32 v149, v79
v_mfma_f32_16x16x32_bf16 v[88:91], a[60:63], a[28:31], v[88:91]
v_exp_f32 v150, v80
v_exp_f32 v151, v81
v_exp_f32 v152, v82
v_exp_f32 v153, v83
v_pk_fma_f32 v[146:147], v[146:147], s[52:53], s[52:53]
v_pk_fma_f32 v[148:149], v[148:149], s[52:53], s[52:53]
v_pk_fma_f32 v[150:151], v[150:151], s[52:53], s[52:53]
v_pk_fma_f32 v[152:153], v[152:153], s[52:53], s[52:53]
v_mfma_f32_16x16x32_bf16 v[88:91], a[56:59], a[24:27], v[88:91]
v_rcp_f32 v146, v146
v_rcp_f32 v147, v147
v_mfma_f32_16x16x32_bf16 v[88:91], v[120:123], a[96:99], v[88:91]
v_rcp_f32 v148, v148
v_rcp_f32 v149, v149
v_mfma_f32_16x16x32_bf16 v[88:91], v[116:119], a[92:95], v[88:91]
v_rcp_f32 v150, v150
v_rcp_f32 v151, v151
v_rcp_f32 v152, v152
v_rcp_f32 v153, v153
s_add_u32 s45, s43, 5120
v_pk_mul_f32 v[76:77], v[76:77], v[146:147] neg_lo:[1,0] neg_hi:[1,0]
v_pk_mul_f32 v[78:79], v[78:79], v[148:149] neg_lo:[1,0] neg_hi:[1,0]
v_pk_mul_f32 v[80:81], v[80:81], v[150:151] neg_lo:[1,0] neg_hi:[1,0]
v_pk_mul_f32 v[82:83], v[82:83], v[152:153] neg_lo:[1,0] neg_hi:[1,0]
v_cvt_pk_bf16_f32 v76, v76, v77
v_cvt_pk_bf16_f32 v77, v78, v79
v_cvt_pk_bf16_f32 v78, v80, v81
v_cvt_pk_bf16_f32 v79, v82, v83
v_pk_fma_f32 v[84:85], v[84:85], v[44:45], v[48:49]
v_pk_fma_f32 v[86:87], v[86:87], v[46:47], v[50:51]
v_pk_fma_f32 v[88:89], v[88:89], v[44:45], v[48:49]
v_pk_fma_f32 v[90:91], v[90:91], v[46:47], v[50:51]
v_permlane16_swap_b32 v76, v78
v_permlane16_swap_b32 v77, v79
buffer_store_dwordx4 v[76:79], v8, s[28:31], s45 offen
v_exp_f32 v146, v84
v_exp_f32 v147, v85
v_exp_f32 v148, v86
v_exp_f32 v149, v87
v_exp_f32 v150, v88
v_exp_f32 v151, v89
v_exp_f32 v152, v90
v_exp_f32 v153, v91
v_pk_fma_f32 v[146:147], v[146:147], s[52:53], s[52:53]
v_pk_fma_f32 v[148:149], v[148:149], s[52:53], s[52:53]
v_pk_fma_f32 v[150:151], v[150:151], s[52:53], s[52:53]
v_pk_fma_f32 v[152:153], v[152:153], s[52:53], s[52:53]
v_rcp_f32 v146, v146
v_rcp_f32 v147, v147
v_rcp_f32 v148, v148
v_rcp_f32 v149, v149
v_rcp_f32 v150, v150
v_rcp_f32 v151, v151
v_rcp_f32 v152, v152
v_rcp_f32 v153, v153
s_add_u32 s46, s43, 7680
v_pk_mul_f32 v[84:85], v[84:85], v[146:147] neg_lo:[1,0] neg_hi:[1,0]
v_pk_mul_f32 v[86:87], v[86:87], v[148:149] neg_lo:[1,0] neg_hi:[1,0]
v_pk_mul_f32 v[88:89], v[88:89], v[150:151] neg_lo:[1,0] neg_hi:[1,0]
v_pk_mul_f32 v[90:91], v[90:91], v[152:153] neg_lo:[1,0] neg_hi:[1,0]
v_cvt_pk_bf16_f32 v84, v84, v85
v_cvt_pk_bf16_f32 v85, v86, v87
v_cvt_pk_bf16_f32 v86, v88, v89
v_cvt_pk_bf16_f32 v87, v90, v91
s_nop 1
v_permlane16_swap_b32 v84, v86
v_permlane16_swap_b32 v85, v87
buffer_store_dwordx4 v[84:87], v8, s[28:31], s46 offen
L_end:
s_endpgm
.section .rodata,"a"
.p2align 6
.amdhsa_kernel standalone__batchnorm__sampling_kernel
  .amdhsa_next_free_vgpr 256
  .amdhsa_next_free_sgpr 96
  .amdhsa_accum_offset 156
  .amdhsa_group_segment_fixed_size 0
  .amdhsa_kernarg_size 72
  .amdhsa_user_sgpr_count 2
  .amdhsa_user_sgpr_kernarg_segment_ptr 1
  .amdhsa_system_sgpr_workgroup_id_x 1
.end_amdhsa_kernel
```
